```python
import torch

def _softmax(x, axis=-1):
    return torch.softmax(x, dim=axis)
def _gelu(x):
    return torch.nn.functional.gelu(x, approximate="tanh")
def _silu(x):
    return torch.nn.functional.silu(x)
def _sigmoid(x):
    return torch.sigmoid(x)
def _layernorm(x, axis=-1, eps=1e-5):
    m = x.mean(dim=axis, keepdim=True)
    v = x.var(dim=axis, keepdim=True, unbiased=False)
    return (x - m) / torch.sqrt(v + eps)
def _scatter_add(tgt, idx, src, axis=0):
    return tgt.clone().index_add_(axis, idx, src)
def _segment_sum(src, seg, n):
    out = torch.zeros((n,) + src.shape[1:], dtype=src.dtype)
    return out.index_add_(0, seg, src)
def _pad(x, pw):
    flat = tuple(v for pair in reversed(pw) for v in pair)
    return torch.nn.functional.pad(x, flat)

kernel_name = 'standalone__self_sup_conv_stem_hubert__speech'

def setup_inputs():

    _w = (lambda a: (lambda t: t.to(torch.bfloat16) if t.is_floating_point() else t)(torch.as_tensor(a)))
    B, T, D, K = 2, 4000, 256, 15
    scale = (1.0 / (K * D)) ** 0.5
    return {
        "x": _w((lambda *s: torch.randn(*s, dtype=torch.bfloat16) * 0.05)(B, T, D)),
        "w": _w((lambda *s: torch.randn(*s, dtype=torch.bfloat16) * 0.05)(K, D, D) * scale),
        "b": _w((lambda *s: torch.randn(*s, dtype=torch.bfloat16) * 0.05)(D) * 0.1),
        "gamma": _w(torch.ones((D,), dtype=float)),
        "beta": _w(torch.zeros((D,), dtype=float)),
    }

def reference(x, w, b, gamma, beta):
    B, T, D = x.shape
    K = w.shape[0]
    s = 2
    L = (T - K) // s + 1
    y = torch.einsum('blc,cd->bld', x[:, 0 : s * L : s, :], w[0])
    for i in range(1, K):
        y = y + torch.einsum('blc,cd->bld', x[:, i : i + s * L : s, :], w[i])
    y = y + b[None, None, :]
    mu = y.mean(1, keepdims=True)
    var = ((y - mu) ** 2).mean(1, keepdims=True)
    yn = (y - mu) / torch.sqrt(var + 1e-5)
    yn = yn * gamma[None, None, :] + beta[None, None, :]
    return _gelu(yn)
```

```asm
; @launch grid=(256,1,1) block=(256,1,1) lds=163840
.amdgcn_target "amdgcn-amd-amdhsa--gfx950"
.text
.globl standalone__self_sup_conv_stem_hubert__speech_kernel
.p2align 8
.type standalone__self_sup_conv_stem_hubert__speech_kernel,@function
standalone__self_sup_conv_stem_hubert__speech_kernel:
    s_cmp_ge_u32 s2, 256
    s_cbranch_scc1 L_end
    s_load_dwordx16 s[4:19], s[0:1], 0
    s_getpc_b64 s[88:89]
L_cpfv:
    s_lshr_b32 s57, s2, 3
    s_lshl_b32 s57, s57, 9
    v_and_b32 v27, 0xc0, v0
    v_lshl_add_u32 v27, v27, 1, s57
    v_min_u32 v27, L_end-L_cpfv, v27
    global_load_dword v247, v27, s[88:89]
    v_and_b32 v1, 63, v0
    v_lshrrev_b32 v26, 6, v0
    v_and_b32 v2, 15, v0
    v_readfirstlane_b32 s40, v26
    v_bfe_u32 v3, v0, 4, 2
    s_and_b32 s43, s2, 7
    s_lshr_b32 s49, s2, 3
    s_lshr_b32 s44, s43, 1
    s_lshl_b32 s44, s44, 3
    s_lshr_b32 s50, s49, 2
    s_add_u32 s44, s44, s50
    s_and_b32 s59, s43, 1
    s_and_b32 s56, s49, 3
    s_lshr_b32 s44, s43, 2
    s_bfe_u32 s50, s43, 0x10001
    s_xor_b32 s44, s44, s50
    s_lshl_b32 s44, s44, 4
    s_lshr_b32 s50, s49, 1
    s_add_u32 s44, s44, s50
    s_and_b32 s56, s43, 2
    s_and_b32 s50, s49, 1
    s_or_b32 s56, s56, s50
    s_lshl_b32 s45, s56, 1
    s_add_u32 s45, s45, s59
    s_lshr_b32 s47, s44, 4
    s_and_b32 s46, s44, 15
    s_add_u32 s95, s44, s56
    s_add_u32 s95, s95, s56
    s_and_b32 s95, s95, 3
    s_lshl_b32 s92, s40, 3
    s_or_b32 s92, s92, 0x70000
    s_lshl_b32 s41, s40, 12
    s_lshr_b32 s93, s40, 1
    s_and_b32 s94, s40, 1
    s_mul_i32 s42, s47, 2048000
    s_lshl_b32 s43, s46, 17
    s_add_u32 s42, s42, s43
    s_lshl_b32 s43, s59, 8
    s_add_u32 s42, s42, s43
    s_lshr_b32 s43, s95, 1
    s_lshl_b32 s43, s43, 7
    s_add_u32 s98, s42, s43
    s_xor_b32 s43, s43, 128
    s_add_u32 s99, s42, s43
    s_lshl_b32 s43, s40, 4
    s_lshl_b64 s[100:101], 0xffff, s43
    v_lshrrev_b32 v26, 3, v1
    v_lshlrev_b32 v28, 10, v26
    v_and_b32 v27, 7, v1
    v_lshl_add_u32 v232, v27, 4, v28
    s_lshl_b32 s43, s94, 6
    s_lshl_b32 s49, s40, 15
    s_or_b32 s43, s43, s49
    v_xor_b32 v228, s43, v232
    v_xor_b32 v229, 0x400, v228
    v_add_u32 v229, 7168, v229
    v_xor_b32 v230, 0x20, v228
    v_add_u32 v230, 14336, v230
    v_xor_b32 v231, 0x420, v228
    v_add_u32 v231, 21504, v231
    v_lshlrev_b32 v26, 9, v26
    v_bfe_u32 v28, v1, 4, 1
    v_lshlrev_b32 v28, 1, v28
    v_xor_b32 v27, v27, v28
    v_lshl_add_u32 v26, v27, 4, v26
    s_lshl_b32 s43, s59, 16
    s_lshl_b32 s49, s56, 7
    s_add_u32 s43, s43, s49
    v_add_u32 v4, s43, v26
    v_xor_b32 v26, 64, v4
    v_add_u32 v5, 3072, v26
    v_add_u32 v6, 6144, v4
    v_add_u32 v7, 9216, v26
    s_mul_i32 s50, s47, 1020416
    s_mov_b32 s26, 1966080
    s_mov_b32 s27, 0x00020000
    s_mov_b32 s22, 4096000
    s_mov_b32 s23, 0x00020000
    s_mov_b32 s34, 2359296
    s_mov_b32 s35, 0x00020000
    s_mov_b32 s38, 256
    s_mov_b32 s39, 0x00020000
    s_mov_b32 s30, 1020416
    s_mov_b32 s31, 0x00020000
L_var0:
    s_waitcnt lgkmcnt(0)
    s_mov_b32 s20, s4
    s_and_b32 s21, s5, 0xffff
    s_mov_b32 s24, s6
    s_and_b32 s25, s7, 0xffff
    s_add_u32 m0, s41, 69632
    s_bfe_u32 s49, 0x30201000, s92
    s_xor_b32 s49, s49, s95
    s_lshl_b32 s49, s49, 14
    buffer_load_dwordx4 v4, s[24:27], s49 offen offset:0 lds
    buffer_load_dwordx4 v5, s[24:27], s49 offen offset:1024 lds
    buffer_load_dwordx4 v6, s[24:27], s49 offen offset:2048 lds
    buffer_load_dwordx4 v7, s[24:27], s49 offen offset:3072 lds
    s_add_u32 m0, s41, 0
    s_add_u32 s43, s98, 0
    buffer_load_dwordx4 v228, s[20:23], s43 offen offset:0 lds
    buffer_load_dwordx4 v229, s[20:23], s43 offen offset:1024 lds
    buffer_load_dwordx4 v230, s[20:23], s43 offen offset:2048 lds
    buffer_load_dwordx4 v231, s[20:23], s43 offen offset:3072 lds
    s_mov_b32 m0, 16384
    s_add_u32 s43, s98, 131072
    s_mov_b64 exec, s[100:101]
    buffer_load_dwordx4 v232, s[20:23], s43 offen lds
    s_mov_b64 exec, -1
    s_add_u32 m0, s41, 86016
    s_bfe_u32 s49, 0x70605040, s92
    s_xor_b32 s49, s49, s95
    s_lshl_b32 s49, s49, 14
    buffer_load_dwordx4 v4, s[24:27], s49 offen offset:0 lds
    buffer_load_dwordx4 v5, s[24:27], s49 offen offset:1024 lds
    buffer_load_dwordx4 v6, s[24:27], s49 offen offset:2048 lds
    buffer_load_dwordx4 v7, s[24:27], s49 offen offset:3072 lds
    s_lshl_b32 s57, s46, 2
    s_add_u32 s57, s57, s40
    s_mul_i32 s57, s57, 14
    v_min_u32 v26, 13, v1
    v_add_u32 v26, s57, v26
    v_lshrrev_b32 v27, 7, v26
    v_lshlrev_b32 v28, 1, v27
    v_cmp_gt_u32 vcc, 0, v27
    v_add_u32 v27, 16, v28
    v_subrev_u32 v28, -1, v28
    v_cndmask_b32 v27, v28, v27, vcc
    v_and_b32 v26, 127, v26
    v_lshlrev_b32 v26, 9, v26
    v_lshl_add_u32 v26, v27, 17, v26
    s_lshl_b32 s57, s59, 16
    s_lshl_b32 s58, s56, 7
    s_add_u32 s57, s57, s58
    buffer_load_dword v246, v26, s[24:27], s57 offen
    s_add_u32 m0, s41, 102400
    s_bfe_u32 s49, 0x31211101, s92
    s_xor_b32 s49, s49, s95
    s_lshl_b32 s49, s49, 14
    buffer_load_dwordx4 v4, s[24:27], s49 offen offset:0 lds
    buffer_load_dwordx4 v5, s[24:27], s49 offen offset:1024 lds
    buffer_load_dwordx4 v6, s[24:27], s49 offen offset:2048 lds
    buffer_load_dwordx4 v7, s[24:27], s49 offen offset:3072 lds
    s_mov_b32 s32, s18
    s_and_b32 s33, s19, 0xffff
    s_mov_b32 s36, s16
    s_and_b32 s37, s17, 0xffff
    s_add_u32 s28, s14, s50
    s_addc_u32 s29, s15, 0
    s_and_b32 s29, s29, 0xffff
    s_lshl_b32 s57, s47, 3
    s_add_u32 s57, s57, s45
    s_lshl_b32 s48, s57, 14
    s_lshr_b32 s57, s57, 1
    s_lshl_b32 s57, s57, 5
    v_mov_b32 v236, s57
    s_mov_b32 s52, 0
    s_mov_b32 s53, 4096
    s_mov_b32 s54, 8192
    s_mov_b32 s55, 12288
    s_and_b32 s57, s95, 1
    s_lshl_b32 s57, s57, 2
    v_or_b32 v30, s57, v3
    s_add_u32 s57, s93, 0
    s_lshr_b32 s58, s57, 1
    s_and_b32 s57, s57, 1
    s_lshl_b32 s57, s57, 9
    v_add_u32 v26, s58, v2
    v_and_b32 v27, 1, v26
    v_lshlrev_b32 v27, 7, v27
    v_and_b32 v29, 6, v26
    v_xor_b32 v29, v29, v30
    v_lshl_add_u32 v27, v29, 4, v27
    v_lshl_add_u32 v27, v26, 10, v27
    v_add_u32 v8, s57, v27
    v_xor_b32 v9, 0x80, v8
    v_xor_b32 v14, 64, v8
    v_xor_b32 v15, 0xc0, v8
    s_add_u32 s57, s93, 1
    s_lshr_b32 s58, s57, 1
    s_and_b32 s57, s57, 1
    s_lshl_b32 s57, s57, 9
    v_add_u32 v26, s58, v2
    v_and_b32 v27, 1, v26
    v_lshlrev_b32 v27, 7, v27
    v_and_b32 v29, 6, v26
    v_xor_b32 v29, v29, v30
    v_lshl_add_u32 v27, v29, 4, v27
    v_lshl_add_u32 v27, v26, 10, v27
    v_add_u32 v10, s57, v27
    v_xor_b32 v11, 0x80, v10
    v_xor_b32 v16, 64, v10
    v_xor_b32 v17, 0xc0, v10
    s_add_u32 s57, s93, 2
    s_lshr_b32 s58, s57, 1
    s_and_b32 s57, s57, 1
    s_lshl_b32 s57, s57, 9
    v_add_u32 v26, s58, v2
    v_and_b32 v27, 1, v26
    v_lshlrev_b32 v27, 7, v27
    v_and_b32 v29, 6, v26
    v_xor_b32 v29, v29, v30
    v_lshl_add_u32 v27, v29, 4, v27
    v_lshl_add_u32 v27, v26, 10, v27
    v_add_u32 v12, s57, v27
    v_xor_b32 v13, 0x80, v12
    v_xor_b32 v18, 64, v12
    v_xor_b32 v19, 0xc0, v12
    v_lshrrev_b32 v26, 2, v2
    v_lshl_add_u32 v27, v3, 3, v26
    v_lshlrev_b32 v27, 7, v27
    v_and_b32 v29, 3, v2
    v_lshl_add_u32 v27, v29, 3, v27
    v_lshrrev_b32 v26, 1, v26
    v_and_b32 v29, 1, v3
    v_lshl_add_u32 v26, v29, 1, v26
    s_lshl_b32 s57, s59, 1
    s_add_u32 s57, s57, s94
    v_xor_b32 v26, s57, v26
    v_lshl_add_u32 v20, v26, 5, v27
    v_xor_b32 v21, 64, v20
    v_add_u32 v22, 69632, v20
    v_add_u32 v23, 69632, v21
    v_add_u32 v24, 135168, v20
    v_add_u32 v25, 135168, v21
    s_lshl_b32 s57, s46, 10
    s_add_u32 s57, s57, s48
    s_lshl_b32 s58, s40, 7
    s_add_u32 s57, s57, s58
    v_lshrrev_b32 v26, 1, v3
    v_lshlrev_b32 v26, 2, v26
    v_lshl_add_u32 v26, v2, 3, v26
    v_add_u32 v233, s57, v26
    s_add_u32 s58, s58, 152576
    v_add_u32 v249, s58, v26
    v_lshlrev_b32 v26, 2, v1
    v_add_u32 v248, 152576, v26
    s_lshl_b32 s57, s46, 10
    s_add_u32 s57, s57, s48
    v_add_u32 v233, s57, v26
    s_lshl_b32 s57, s40, 12
    s_add_u32 s57, s57, s48
    v_lshlrev_b32 v27, 4, v2
    v_lshl_add_u32 v29, v3, 10, v27
    v_add_u32 v239, s57, v29
    s_lshl_b32 s57, s94, 7
    s_add_u32 s57, s57, s48
    v_lshlrev_b32 v29, 3, v2
    v_lshl_add_u32 v29, v3, 10, v29
    v_add_u32 v239, s57, v29
    s_lshl_b32 s57, s40, 8
    s_add_u32 s57, s57, 151552
    v_lshl_add_u32 v27, v3, 2, v27
    v_add_u32 v240, s57, v27
    s_lshl_b32 s57, s94, 7
    s_add_u32 s57, s57, 151552
    v_lshlrev_b32 v27, 3, v2
    v_add_u32 v241, s57, v27
    s_lshl_b32 s57, s45, 6
    s_lshl_b32 s58, s94, 5
    s_add_u32 s57, s57, s58
    v_lshlrev_b32 v245, 1, v2
    v_add_u32 v245, s57, v245
    s_lshl_b32 s58, s46, 16
    s_add_u32 s57, s57, s58
    s_lshl_b32 s58, s93, 11
    s_add_u32 s57, s57, s58
    v_and_b32 v26, 1, v2
    v_and_b32 v27, 14, v2
    v_lshlrev_b32 v27, 1, v27
    v_lshl_add_u32 v27, v26, 9, v27
    v_lshl_add_u32 v27, v3, 14, v27
    v_add_u32 v237, s57, v27
    v_mov_b32 v238, 0x05040100
    v_mov_b32 v27, 0x03020706
    v_cmp_eq_u32 vcc, 1, v26
    s_lshl_b32 s57, s46, 7
    s_lshl_b32 s58, s93, 2
    v_cndmask_b32 v238, v238, v27, vcc
    s_add_u32 s57, s57, s58
    s_sub_u32 s57, 1993, s57
    v_lshlrev_b32 v26, 5, v3
    v_sub_u32 v26, s57, v26
    v_cmp_lt_i32 s[60:61], 0, v26
    v_cmp_lt_i32 s[62:63], 8, v26
    v_cmp_lt_i32 s[64:65], 16, v26
    v_cmp_lt_i32 s[66:67], 24, v26
    v_cmp_lt_i32 s[68:69], 1, v26
    v_cmp_lt_i32 s[70:71], 9, v26
    v_cmp_lt_i32 s[72:73], 17, v26
    v_cmp_lt_i32 s[74:75], 25, v26
    v_cmp_lt_i32 s[76:77], 2, v26
    v_cmp_lt_i32 s[78:79], 10, v26
    v_cmp_lt_i32 s[80:81], 18, v26
    v_cmp_lt_i32 s[82:83], 26, v26
    v_cmp_lt_i32 s[84:85], 3, v26
    v_cmp_lt_i32 s[86:87], 11, v26
    v_cmp_lt_i32 s[88:89], 19, v26
    v_cmp_lt_i32 s[90:91], 27, v26
    s_lshl_b32 s57, s44, 3
    s_add_u32 s57, s57, s45
    s_lshl_b32 s57, s57, 13
    s_lshl_b32 s58, s40, 11
    s_add_u32 s57, s57, s58
    s_add_u32 s57, s57, 262144
    v_lshlrev_b32 v26, 4, v1
    v_add_u32 v235, s57, v26
    v_xor_b32 v234, 0x2000, v235
    v_accvgpr_write_b32 a0, -1
    v_accvgpr_write_b32 a1, -1
    v_accvgpr_write_b32 a2, -1
    v_accvgpr_write_b32 a3, -1
    s_getreg_b32 s57, hwreg(HW_REG_XCC_ID, 0, 4)
    s_add_u32 s57, s57, 1
    s_mul_i32 s58, s57, s57
    s_lshl_b32 s58, s58, 9
    s_or_b32 s0, s58, s57
    s_lshl_b32 s57, s0, 8
    s_lshl_b32 s0, s0, 4
    s_cmp_eq_u32 s59, 0
    s_cselect_b32 s58, s57, 0
    s_cselect_b32 s57, 0, s57
    s_add_u32 s58, s58, 1
    v_mov_b32 v250, s58
    v_mov_b32 v251, s57
    s_waitcnt vmcnt(9)
    s_barrier
    ds_read_b64_tr_b16 v[32:33], v23 offset:0
    ds_read_b64_tr_b16 v[34:35], v23 offset:512
    ds_read_b128 v[64:67], v8 offset:0
    ds_read_b128 v[68:71], v9 offset:0
    ds_read_b128 v[72:75], v8 offset:256
    ds_read_b128 v[76:79], v9 offset:256
    ds_read_b128 v[80:83], v10 offset:0
    ds_read_b64_tr_b16 v[48:49], v22 offset:0
    ds_read_b64_tr_b16 v[50:51], v22 offset:512
    ds_read_b64_tr_b16 v[52:53], v22 offset:4096
    ds_read_b64_tr_b16 v[54:55], v22 offset:4608
    ds_read_b64_tr_b16 v[36:37], v23 offset:4096
    ds_read_b64_tr_b16 v[38:39], v23 offset:4608
    s_waitcnt lgkmcnt(10)
    v_mfma_f32_16x16x32_bf16 v[212:215], v[64:67], v[32:35], 0
    ds_read_b64_tr_b16 v[56:57], v22 offset:8192
    s_add_u32 m0, s41, 118784
    s_bfe_u32 s49, 0x71615141, s92
    s_waitcnt lgkmcnt(10)
    v_mfma_f32_16x16x32_bf16 v[216:219], v[68:71], v[32:35], 0
    ds_read_b64_tr_b16 v[58:59], v22 offset:8704
    s_xor_b32 s49, s49, s95
    s_lshl_b32 s49, s49, 14
    s_waitcnt lgkmcnt(10)
    v_mfma_f32_16x16x32_bf16 v[220:223], v[72:75], v[32:35], 0
    ds_read_b64_tr_b16 v[40:41], v23 offset:8192
    buffer_load_dwordx4 v4, s[24:27], s49 offen offset:0 lds
    s_waitcnt lgkmcnt(10)
    v_mfma_f32_16x16x32_bf16 v[224:227], v[76:79], v[32:35], 0
    ds_read_b64_tr_b16 v[42:43], v23 offset:8704
    s_waitcnt lgkmcnt(8)
    v_mfma_f32_16x16x32_bf16 v[196:199], v[64:67], v[48:51], 0
    ds_read_b128 v[84:87], v11 offset:0
    v_mfma_f32_16x16x32_bf16 v[200:203], v[68:71], v[48:51], 0
    ds_read_b128 v[88:91], v10 offset:256
    v_mfma_f32_16x16x32_bf16 v[204:207], v[72:75], v[48:51], 0
    ds_read_b128 v[92:95], v11 offset:256
    v_mfma_f32_16x16x32_bf16 v[208:211], v[76:79], v[48:51], 0
    buffer_load_dwordx4 v5, s[24:27], s49 offen offset:1024 lds
    s_waitcnt lgkmcnt(7)
    v_mfma_f32_16x16x32_bf16 v[212:215], v[68:71], v[36:39], v[212:215]
    ds_read_b64_tr_b16 v[60:61], v22 offset:12288
    buffer_load_dwordx4 v6, s[24:27], s49 offen offset:2048 lds
    v_mfma_f32_16x16x32_bf16 v[216:219], v[72:75], v[36:39], v[216:219]
    ds_read_b64_tr_b16 v[62:63], v22 offset:12800
    v_mfma_f32_16x16x32_bf16 v[220:223], v[76:79], v[36:39], v[220:223]
    ds_read_b64_tr_b16 v[44:45], v23 offset:12288
    v_mfma_f32_16x16x32_bf16 v[224:227], v[80:83], v[36:39], v[224:227]
    ds_read_b64_tr_b16 v[46:47], v23 offset:12800
    v_mfma_f32_16x16x32_bf16 v[196:199], v[68:71], v[52:55], v[196:199]
    ds_read_b128 v[96:99], v12 offset:0
    v_mfma_f32_16x16x32_bf16 v[200:203], v[72:75], v[52:55], v[200:203]
    ds_read_b128 v[100:103], v13 offset:0
    v_mfma_f32_16x16x32_bf16 v[204:207], v[76:79], v[52:55], v[204:207]
    ds_read_b128 v[104:107], v12 offset:256
    v_mfma_f32_16x16x32_bf16 v[208:211], v[80:83], v[52:55], v[208:211]
    s_waitcnt vmcnt(8)
    s_barrier
    s_waitcnt lgkmcnt(10)
    v_mfma_f32_16x16x32_bf16 v[212:215], v[72:75], v[40:43], v[212:215]
    ds_read_b64_tr_b16 v[48:49], v22 offset:16384
    buffer_load_dwordx4 v7, s[24:27], s49 offen offset:3072 lds
    v_mfma_f32_16x16x32_bf16 v[216:219], v[76:79], v[40:43], v[216:219]
    ds_read_b64_tr_b16 v[50:51], v22 offset:16896
    s_add_u32 m0, s41, 17408
    s_add_u32 s43, s98, 512
    v_mfma_f32_16x16x32_bf16 v[220:223], v[80:83], v[40:43], v[220:223]
    ds_read_b64_tr_b16 v[32:33], v23 offset:16384
    buffer_load_dwordx4 v228, s[20:23], s43 offen offset:0 lds
    s_waitcnt lgkmcnt(12)
    v_mfma_f32_16x16x32_bf16 v[224:227], v[84:87], v[40:43], v[224:227]
    ds_read_b64_tr_b16 v[34:35], v23 offset:16896
    v_mfma_f32_16x16x32_bf16 v[196:199], v[72:75], v[56:59], v[196:199]
    ds_read_b128 v[108:111], v14 offset:0
    v_mfma_f32_16x16x32_bf16 v[200:203], v[76:79], v[56:59], v[200:203]
    ds_read_b128 v[112:115], v15 offset:0
    v_mfma_f32_16x16x32_bf16 v[204:207], v[80:83], v[56:59], v[204:207]
    ds_read_b128 v[116:119], v14 offset:256
    v_mfma_f32_16x16x32_bf16 v[208:211], v[84:87], v[56:59], v[208:211]
    buffer_load_dwordx4 v229, s[20:23], s43 offen offset:1024 lds
    s_waitcnt lgkmcnt(10)
    v_mfma_f32_16x16x32_bf16 v[212:215], v[76:79], v[44:47], v[212:215]
    ds_read_b64_tr_b16 v[52:53], v22 offset:20480
    buffer_load_dwordx4 v230, s[20:23], s43 offen offset:2048 lds
    v_mfma_f32_16x16x32_bf16 v[216:219], v[80:83], v[44:47], v[216:219]
    ds_read_b64_tr_b16 v[54:55], v22 offset:20992
    v_mfma_f32_16x16x32_bf16 v[220:223], v[84:87], v[44:47], v[220:223]
    ds_read_b64_tr_b16 v[36:37], v23 offset:20480
    v_mfma_f32_16x16x32_bf16 v[224:227], v[88:91], v[44:47], v[224:227]
    ds_read_b64_tr_b16 v[38:39], v23 offset:20992
    v_mfma_f32_16x16x32_bf16 v[196:199], v[76:79], v[60:63], v[196:199]
    ds_read_b128 v[120:123], v15 offset:256
    v_mfma_f32_16x16x32_bf16 v[200:203], v[80:83], v[60:63], v[200:203]
    ds_read_b128 v[124:127], v16 offset:0
    v_mfma_f32_16x16x32_bf16 v[204:207], v[84:87], v[60:63], v[204:207]
    ds_read_b128 v[128:131], v17 offset:0
    v_mfma_f32_16x16x32_bf16 v[208:211], v[88:91], v[60:63], v[208:211]
    buffer_load_dwordx4 v231, s[20:23], s43 offen offset:3072 lds
    s_waitcnt lgkmcnt(10)
    v_mfma_f32_16x16x32_bf16 v[212:215], v[80:83], v[32:35], v[212:215]
    ds_read_b64_tr_b16 v[56:57], v22 offset:24576
    v_mfma_f32_16x16x32_bf16 v[216:219], v[84:87], v[32:35], v[216:219]
    ds_read_b64_tr_b16 v[58:59], v22 offset:25088
    v_mfma_f32_16x16x32_bf16 v[220:223], v[88:91], v[32:35], v[220:223]
    ds_read_b64_tr_b16 v[40:41], v23 offset:24576
    v_mfma_f32_16x16x32_bf16 v[224:227], v[92:95], v[32:35], v[224:227]
    ds_read_b64_tr_b16 v[42:43], v23 offset:25088
    v_mfma_f32_16x16x32_bf16 v[196:199], v[80:83], v[48:51], v[196:199]
    ds_read_b128 v[132:135], v16 offset:256
    v_mfma_f32_16x16x32_bf16 v[200:203], v[84:87], v[48:51], v[200:203]
    ds_read_b128 v[136:139], v17 offset:256
    v_mfma_f32_16x16x32_bf16 v[204:207], v[88:91], v[48:51], v[204:207]
    ds_read_b128 v[140:143], v18 offset:0
    v_mfma_f32_16x16x32_bf16 v[208:211], v[92:95], v[48:51], v[208:211]
    s_mov_b32 m0, 33792
    s_add_u32 s43, s98, 131584
    s_waitcnt lgkmcnt(10)
    v_mfma_f32_16x16x32_bf16 v[212:215], v[84:87], v[36:39], v[212:215]
    ds_read_b64_tr_b16 v[60:61], v22 offset:28672
    s_mov_b64 exec, s[100:101]
    buffer_load_dwordx4 v232, s[20:23], s43 offen lds
    s_mov_b64 exec, -1
    v_mfma_f32_16x16x32_bf16 v[216:219], v[88:91], v[36:39], v[216:219]
    ds_read_b64_tr_b16 v[62:63], v22 offset:29184
    s_add_u32 m0, s41, 135168
    s_bfe_u32 s49, 0x38281808, s92
    v_mfma_f32_16x16x32_bf16 v[220:223], v[92:95], v[36:39], v[220:223]
    ds_read_b64_tr_b16 v[44:45], v23 offset:28672
    s_xor_b32 s49, s49, s95
    s_lshl_b32 s49, s49, 14
    v_mfma_f32_16x16x32_bf16 v[224:227], v[96:99], v[36:39], v[224:227]
    ds_read_b64_tr_b16 v[46:47], v23 offset:29184
    v_mfma_f32_16x16x32_bf16 v[196:199], v[84:87], v[52:55], v[196:199]
    ds_read_b128 v[144:147], v19 offset:0
    v_mfma_f32_16x16x32_bf16 v[200:203], v[88:91], v[52:55], v[200:203]
    ds_read_b128 v[148:151], v18 offset:256
    v_mfma_f32_16x16x32_bf16 v[204:207], v[92:95], v[52:55], v[204:207]
    buffer_load_dwordx4 v4, s[24:27], s49 offen offset:0 lds
    v_mfma_f32_16x16x32_bf16 v[208:211], v[96:99], v[52:55], v[208:211]
    s_waitcnt vmcnt(10)
    s_barrier
    s_waitcnt lgkmcnt(9)
    v_mfma_f32_16x16x32_bf16 v[212:215], v[88:91], v[40:43], v[212:215]
    ds_read_b64_tr_b16 v[48:49], v22 offset:32768
    v_mfma_f32_16x16x32_bf16 v[216:219], v[92:95], v[40:43], v[216:219]
    ds_read_b64_tr_b16 v[50:51], v22 offset:33280
    v_mfma_f32_16x16x32_bf16 v[220:223], v[96:99], v[40:43], v[220:223]
    ds_read_b64_tr_b16 v[32:33], v23 offset:32768
    v_mfma_f32_16x16x32_bf16 v[224:227], v[100:103], v[40:43], v[224:227]
    ds_read_b64_tr_b16 v[34:35], v23 offset:33280
    v_mfma_f32_16x16x32_bf16 v[196:199], v[88:91], v[56:59], v[196:199]
    buffer_load_dwordx4 v5, s[24:27], s49 offen offset:1024 lds
    v_mfma_f32_16x16x32_bf16 v[200:203], v[92:95], v[56:59], v[200:203]
    buffer_load_dwordx4 v6, s[24:27], s49 offen offset:2048 lds
    v_mfma_f32_16x16x32_bf16 v[204:207], v[96:99], v[56:59], v[204:207]
    v_mfma_f32_16x16x32_bf16 v[208:211], v[100:103], v[56:59], v[208:211]
    buffer_load_dwordx4 v7, s[24:27], s49 offen offset:3072 lds
    s_waitcnt lgkmcnt(6)
    v_mfma_f32_16x16x32_bf16 v[212:215], v[92:95], v[44:47], v[212:215]
    ds_read_b64_tr_b16 v[52:53], v22 offset:36864
    v_mfma_f32_16x16x32_bf16 v[216:219], v[96:99], v[44:47], v[216:219]
    ds_read_b64_tr_b16 v[54:55], v22 offset:37376
    v_mfma_f32_16x16x32_bf16 v[220:223], v[100:103], v[44:47], v[220:223]
    ds_read_b64_tr_b16 v[36:37], v23 offset:36864
    v_mfma_f32_16x16x32_bf16 v[224:227], v[104:107], v[44:47], v[224:227]
    ds_read_b64_tr_b16 v[38:39], v23 offset:37376
    v_mfma_f32_16x16x32_bf16 v[196:199], v[92:95], v[60:63], v[196:199]
    s_add_u32 m0, s41, 69632
    s_bfe_u32 s49, 0x9685848, s92
    v_mfma_f32_16x16x32_bf16 v[200:203], v[96:99], v[60:63], v[200:203]
    s_xor_b32 s49, s49, s95
    s_lshl_b32 s49, s49, 14
    v_mfma_f32_16x16x32_bf16 v[204:207], v[100:103], v[60:63], v[204:207]
    buffer_load_dwordx4 v4, s[24:27], s49 offen offset:0 lds
    v_mfma_f32_16x16x32_bf16 v[208:211], v[104:107], v[60:63], v[208:211]
    s_waitcnt lgkmcnt(4)
    v_mfma_f32_16x16x32_bf16 v[212:215], v[108:111], v[32:35], v[212:215]
    ds_read_b64_tr_b16 v[56:57], v22 offset:40960
    v_mfma_f32_16x16x32_bf16 v[216:219], v[112:115], v[32:35], v[216:219]
    ds_read_b64_tr_b16 v[58:59], v22 offset:41472
    v_mfma_f32_16x16x32_bf16 v[220:223], v[116:119], v[32:35], v[220:223]
    ds_read_b64_tr_b16 v[40:41], v23 offset:40960
    v_mfma_f32_16x16x32_bf16 v[224:227], v[120:123], v[32:35], v[224:227]
    ds_read_b64_tr_b16 v[42:43], v23 offset:41472
    v_mfma_f32_16x16x32_bf16 v[196:199], v[108:111], v[48:51], v[196:199]
    buffer_load_dwordx4 v5, s[24:27], s49 offen offset:1024 lds
    v_mfma_f32_16x16x32_bf16 v[200:203], v[112:115], v[48:51], v[200:203]
    v_mfma_f32_16x16x32_bf16 v[204:207], v[116:119], v[48:51], v[204:207]
    v_mfma_f32_16x16x32_bf16 v[208:211], v[120:123], v[48:51], v[208:211]
    s_waitcnt lgkmcnt(4)
    v_mfma_f32_16x16x32_bf16 v[212:215], v[112:115], v[36:39], v[212:215]
    ds_read_b64_tr_b16 v[60:61], v22 offset:45056
    v_mfma_f32_16x16x32_bf16 v[216:219], v[116:119], v[36:39], v[216:219]
    ds_read_b64_tr_b16 v[62:63], v22 offset:45568
    v_mfma_f32_16x16x32_bf16 v[220:223], v[120:123], v[36:39], v[220:223]
    ds_read_b64_tr_b16 v[44:45], v23 offset:45056
    v_mfma_f32_16x16x32_bf16 v[224:227], v[124:127], v[36:39], v[224:227]
    ds_read_b64_tr_b16 v[46:47], v23 offset:45568
    v_mfma_f32_16x16x32_bf16 v[196:199], v[112:115], v[52:55], v[196:199]
    buffer_load_dwordx4 v6, s[24:27], s49 offen offset:2048 lds
    v_mfma_f32_16x16x32_bf16 v[200:203], v[116:119], v[52:55], v[200:203]
    buffer_load_dwordx4 v7, s[24:27], s49 offen offset:3072 lds
    v_mfma_f32_16x16x32_bf16 v[204:207], v[120:123], v[52:55], v[204:207]
    v_mfma_f32_16x16x32_bf16 v[208:211], v[124:127], v[52:55], v[208:211]
    s_waitcnt vmcnt(8)
    s_barrier
    s_waitcnt lgkmcnt(4)
    v_mfma_f32_16x16x32_bf16 v[212:215], v[116:119], v[40:43], v[212:215]
    ds_read_b64_tr_b16 v[48:49], v22 offset:49152
    s_add_u32 m0, s41, 34816
    s_add_u32 s43, s99, 0
    v_mfma_f32_16x16x32_bf16 v[216:219], v[120:123], v[40:43], v[216:219]
    ds_read_b64_tr_b16 v[50:51], v22 offset:49664
    buffer_load_dwordx4 v228, s[20:23], s43 offen offset:0 lds
    v_mfma_f32_16x16x32_bf16 v[220:223], v[124:127], v[40:43], v[220:223]
    ds_read_b64_tr_b16 v[32:33], v23 offset:49152
    v_mfma_f32_16x16x32_bf16 v[224:227], v[128:131], v[40:43], v[224:227]
    ds_read_b64_tr_b16 v[34:35], v23 offset:49664
    v_mfma_f32_16x16x32_bf16 v[196:199], v[116:119], v[56:59], v[196:199]
    ds_read_b128 v[152:155], v8 offset:17408
    v_mfma_f32_16x16x32_bf16 v[200:203], v[120:123], v[56:59], v[200:203]
    ds_read_b128 v[156:159], v9 offset:17408
    v_mfma_f32_16x16x32_bf16 v[204:207], v[124:127], v[56:59], v[204:207]
    buffer_load_dwordx4 v229, s[20:23], s43 offen offset:1024 lds
    v_mfma_f32_16x16x32_bf16 v[208:211], v[128:131], v[56:59], v[208:211]
    buffer_load_dwordx4 v230, s[20:23], s43 offen offset:2048 lds
    s_waitcnt lgkmcnt(6)
    v_mfma_f32_16x16x32_bf16 v[212:215], v[120:123], v[44:47], v[212:215]
    ds_read_b64_tr_b16 v[52:53], v22 offset:53248
    v_mfma_f32_16x16x32_bf16 v[216:219], v[124:127], v[44:47], v[216:219]
    ds_read_b64_tr_b16 v[54:55], v22 offset:53760
    v_mfma_f32_16x16x32_bf16 v[220:223], v[128:131], v[44:47], v[220:223]
    ds_read_b64_tr_b16 v[36:37], v23 offset:53248
    v_mfma_f32_16x16x32_bf16 v[224:227], v[132:135], v[44:47], v[224:227]
    ds_read_b64_tr_b16 v[38:39], v23 offset:53760
    v_mfma_f32_16x16x32_bf16 v[196:199], v[120:123], v[60:63], v[196:199]
    ds_read_b128 v[160:163], v8 offset:17664
    v_mfma_f32_16x16x32_bf16 v[200:203], v[124:127], v[60:63], v[200:203]
    ds_read_b128 v[164:167], v9 offset:17664
    v_mfma_f32_16x16x32_bf16 v[204:207], v[128:131], v[60:63], v[204:207]
    buffer_load_dwordx4 v231, s[20:23], s43 offen offset:3072 lds
    v_mfma_f32_16x16x32_bf16 v[208:211], v[132:135], v[60:63], v[208:211]
    s_waitcnt lgkmcnt(8)
    v_mfma_f32_16x16x32_bf16 v[212:215], v[124:127], v[32:35], v[212:215]
    ds_read_b64_tr_b16 v[56:57], v22 offset:57344
    v_mfma_f32_16x16x32_bf16 v[216:219], v[128:131], v[32:35], v[216:219]
    ds_read_b64_tr_b16 v[58:59], v22 offset:57856
    v_mfma_f32_16x16x32_bf16 v[220:223], v[132:135], v[32:35], v[220:223]
    ds_read_b64_tr_b16 v[40:41], v23 offset:57344
    v_mfma_f32_16x16x32_bf16 v[224:227], v[136:139], v[32:35], v[224:227]
    ds_read_b64_tr_b16 v[42:43], v23 offset:57856
    v_mfma_f32_16x16x32_bf16 v[196:199], v[124:127], v[48:51], v[196:199]
    ds_read_b128 v[168:171], v10 offset:17408
    v_mfma_f32_16x16x32_bf16 v[200:203], v[128:131], v[48:51], v[200:203]
    s_mov_b32 m0, 51200
    s_add_u32 s43, s99, 131072
    v_mfma_f32_16x16x32_bf16 v[204:207], v[132:135], v[48:51], v[204:207]
    s_mov_b64 exec, s[100:101]
    buffer_load_dwordx4 v232, s[20:23], s43 offen lds
    s_mov_b64 exec, -1
    v_mfma_f32_16x16x32_bf16 v[208:211], v[136:139], v[48:51], v[208:211]
    s_add_u32 m0, s41, 86016
    s_bfe_u32 s49, 0x49392919, s92
    s_waitcnt lgkmcnt(7)
    v_mfma_f32_16x16x32_bf16 v[212:215], v[128:131], v[36:39], v[212:215]
    ds_read_b64_tr_b16 v[60:61], v22 offset:61440
    s_xor_b32 s49, s49, s95
    s_lshl_b32 s49, s49, 14
    v_mfma_f32_16x16x32_bf16 v[216:219], v[132:135], v[36:39], v[216:219]
    ds_read_b64_tr_b16 v[62:63], v22 offset:61952
    buffer_load_dwordx4 v4, s[24:27], s49 offen offset:0 lds
    v_mfma_f32_16x16x32_bf16 v[220:223], v[136:139], v[36:39], v[220:223]
    ds_read_b64_tr_b16 v[44:45], v23 offset:61440
    v_mfma_f32_16x16x32_bf16 v[224:227], v[140:143], v[36:39], v[224:227]
    ds_read_b64_tr_b16 v[46:47], v23 offset:61952
    v_mfma_f32_16x16x32_bf16 v[196:199], v[128:131], v[52:55], v[196:199]
    ds_read_b128 v[172:175], v11 offset:17408
    v_mfma_f32_16x16x32_bf16 v[200:203], v[132:135], v[52:55], v[200:203]
    ds_read_b128 v[176:179], v10 offset:17664
    v_mfma_f32_16x16x32_bf16 v[204:207], v[136:139], v[52:55], v[204:207]
    buffer_load_dwordx4 v5, s[24:27], s49 offen offset:1024 lds
    v_mfma_f32_16x16x32_bf16 v[208:211], v[140:143], v[52:55], v[208:211]
    s_waitcnt vmcnt(11)
    s_barrier
    s_waitcnt lgkmcnt(7)
    v_mfma_f32_16x16x32_bf16 v[212:215], v[132:135], v[40:43], v[212:215]
    ds_read_b64_tr_b16 v[48:49], v24 offset:0
    buffer_load_dwordx4 v6, s[24:27], s49 offen offset:2048 lds
    v_mfma_f32_16x16x32_bf16 v[216:219], v[136:139], v[40:43], v[216:219]
    ds_read_b64_tr_b16 v[50:51], v24 offset:512
    v_mfma_f32_16x16x32_bf16 v[220:223], v[140:143], v[40:43], v[220:223]
    ds_read_b64_tr_b16 v[32:33], v25 offset:0
    v_mfma_f32_16x16x32_bf16 v[224:227], v[144:147], v[40:43], v[224:227]
    ds_read_b64_tr_b16 v[34:35], v25 offset:512
    v_mfma_f32_16x16x32_bf16 v[196:199], v[132:135], v[56:59], v[196:199]
    ds_read_b128 v[180:183], v11 offset:17664
    v_mfma_f32_16x16x32_bf16 v[200:203], v[136:139], v[56:59], v[200:203]
    ds_read_b128 v[184:187], v12 offset:17408
    v_mfma_f32_16x16x32_bf16 v[204:207], v[140:143], v[56:59], v[204:207]
    buffer_load_dwordx4 v7, s[24:27], s49 offen offset:3072 lds
    v_mfma_f32_16x16x32_bf16 v[208:211], v[144:147], v[56:59], v[208:211]
    s_add_u32 m0, s41, 52224
    s_add_u32 s43, s99, 512
    s_waitcnt lgkmcnt(8)
    v_mfma_f32_16x16x32_bf16 v[212:215], v[136:139], v[44:47], v[212:215]
    ds_read_b64_tr_b16 v[52:53], v24 offset:4096
    v_mfma_f32_16x16x32_bf16 v[216:219], v[140:143], v[44:47], v[216:219]
    ds_read_b64_tr_b16 v[54:55], v24 offset:4608
    v_mfma_f32_16x16x32_bf16 v[220:223], v[144:147], v[44:47], v[220:223]
    ds_read_b64_tr_b16 v[36:37], v25 offset:4096
    v_mfma_f32_16x16x32_bf16 v[224:227], v[148:151], v[44:47], v[224:227]
    ds_read_b64_tr_b16 v[38:39], v25 offset:4608
    v_mfma_f32_16x16x32_bf16 v[196:199], v[136:139], v[60:63], v[196:199]
    ds_read_b128 v[188:191], v13 offset:17408
    v_mfma_f32_16x16x32_bf16 v[200:203], v[140:143], v[60:63], v[200:203]
    buffer_load_dwordx4 v228, s[20:23], s43 offen offset:0 lds
    v_mfma_f32_16x16x32_bf16 v[204:207], v[144:147], v[60:63], v[204:207]
    buffer_load_dwordx4 v229, s[20:23], s43 offen offset:1024 lds
    v_mfma_f32_16x16x32_bf16 v[208:211], v[148:151], v[60:63], v[208:211]
    s_waitcnt lgkmcnt(7)
    v_mfma_f32_16x16x32_bf16 v[212:215], v[152:155], v[32:35], v[212:215]
    ds_read_b64_tr_b16 v[56:57], v24 offset:8192
    v_mfma_f32_16x16x32_bf16 v[216:219], v[156:159], v[32:35], v[216:219]
    ds_read_b64_tr_b16 v[58:59], v24 offset:8704
    v_mfma_f32_16x16x32_bf16 v[220:223], v[160:163], v[32:35], v[220:223]
    ds_read_b64_tr_b16 v[40:41], v25 offset:8192
    v_mfma_f32_16x16x32_bf16 v[224:227], v[164:167], v[32:35], v[224:227]
    ds_read_b64_tr_b16 v[42:43], v25 offset:8704
    v_mfma_f32_16x16x32_bf16 v[196:199], v[152:155], v[48:51], v[196:199]
    ds_read_b128 a[12:15], v14 offset:17408
    v_mfma_f32_16x16x32_bf16 v[200:203], v[156:159], v[48:51], v[200:203]
    ds_read_b128 a[16:19], v15 offset:17408
    v_mfma_f32_16x16x32_bf16 v[204:207], v[160:163], v[48:51], v[204:207]
    buffer_load_dwordx4 v230, s[20:23], s43 offen offset:2048 lds
    v_mfma_f32_16x16x32_bf16 v[208:211], v[164:167], v[48:51], v[208:211]
    buffer_load_dwordx4 v231, s[20:23], s43 offen offset:3072 lds
    s_waitcnt lgkmcnt(7)
    v_mfma_f32_16x16x32_bf16 v[212:215], v[156:159], v[36:39], v[212:215]
    ds_read_b64_tr_b16 v[60:61], v24 offset:12288
    s_mov_b32 m0, 68608
    s_add_u32 s43, s99, 131584
    v_mfma_f32_16x16x32_bf16 v[216:219], v[160:163], v[36:39], v[216:219]
    ds_read_b64_tr_b16 v[62:63], v24 offset:12800
    v_mfma_f32_16x16x32_bf16 v[220:223], v[164:167], v[36:39], v[220:223]
    ds_read_b64_tr_b16 v[44:45], v25 offset:12288
    v_mfma_f32_16x16x32_bf16 v[224:227], v[168:171], v[36:39], v[224:227]
    ds_read_b64_tr_b16 v[46:47], v25 offset:12800
    v_mfma_f32_16x16x32_bf16 v[196:199], v[156:159], v[52:55], v[196:199]
    ds_read_b128 a[20:23], v14 offset:17664
    v_mfma_f32_16x16x32_bf16 v[200:203], v[160:163], v[52:55], v[200:203]
    ds_read_b128 a[24:27], v15 offset:17664
    v_mfma_f32_16x16x32_bf16 v[204:207], v[164:167], v[52:55], v[204:207]
    s_mov_b64 exec, s[100:101]
    buffer_load_dwordx4 v232, s[20:23], s43 offen lds
    s_mov_b64 exec, -1
    v_mfma_f32_16x16x32_bf16 v[208:211], v[168:171], v[52:55], v[208:211]
    s_waitcnt vmcnt(9)
    s_barrier
    s_waitcnt lgkmcnt(8)
    v_mfma_f32_16x16x32_bf16 v[212:215], v[160:163], v[40:43], v[212:215]
    ds_read_b64_tr_b16 v[48:49], v22 offset:0
    s_add_u32 m0, s41, 102400
    s_bfe_u32 s49, 0x12026959, s92
    v_mfma_f32_16x16x32_bf16 v[216:219], v[164:167], v[40:43], v[216:219]
    ds_read_b64_tr_b16 v[50:51], v22 offset:512
    s_xor_b32 s49, s49, s95
    s_lshl_b32 s49, s49, 14
    v_mfma_f32_16x16x32_bf16 v[220:223], v[168:171], v[40:43], v[220:223]
    ds_read_b64_tr_b16 v[32:33], v23 offset:0
    buffer_load_dwordx4 v4, s[24:27], s49 offen offset:0 lds
    v_mfma_f32_16x16x32_bf16 v[224:227], v[172:175], v[40:43], v[224:227]
    ds_read_b64_tr_b16 v[34:35], v23 offset:512
    buffer_load_dwordx4 v5, s[24:27], s49 offen offset:1024 lds
    v_mfma_f32_16x16x32_bf16 v[196:199], v[160:163], v[56:59], v[196:199]
    ds_read_b128 a[28:31], v16 offset:17408
    v_mfma_f32_16x16x32_bf16 v[200:203], v[164:167], v[56:59], v[200:203]
    ds_read_b128 v[64:67], v8 offset:34816
    v_mfma_f32_16x16x32_bf16 v[204:207], v[168:171], v[56:59], v[204:207]
    ds_read_b128 v[68:71], v9 offset:34816
    v_mfma_f32_16x16x32_bf16 v[208:211], v[172:175], v[56:59], v[208:211]
    buffer_load_dwordx4 v6, s[24:27], s49 offen offset:2048 lds
    s_waitcnt lgkmcnt(9)
    v_mfma_f32_16x16x32_bf16 v[212:215], v[164:167], v[44:47], v[212:215]
    ds_read_b64_tr_b16 v[52:53], v22 offset:4096
    buffer_load_dwordx4 v7, s[24:27], s49 offen offset:3072 lds
    v_mfma_f32_16x16x32_bf16 v[216:219], v[168:171], v[44:47], v[216:219]
    ds_read_b64_tr_b16 v[54:55], v22 offset:4608
    buffer_store_dwordx4 a[0:3], v234, s[32:35], 0 offen offset:0 sc0 sc1
    v_mfma_f32_16x16x32_bf16 v[220:223], v[172:175], v[44:47], v[220:223]
    ds_read_b64_tr_b16 v[36:37], v23 offset:4096
    v_mfma_f32_16x16x32_bf16 v[224:227], v[176:179], v[44:47], v[224:227]
    ds_read_b64_tr_b16 v[38:39], v23 offset:4608
    v_mfma_f32_16x16x32_bf16 v[196:199], v[164:167], v[60:63], v[196:199]
    ds_read_b128 a[32:35], v17 offset:17408
    v_mfma_f32_16x16x32_bf16 v[200:203], v[168:171], v[60:63], v[200:203]
    ds_read_b128 a[36:39], v16 offset:17664
    v_mfma_f32_16x16x32_bf16 v[204:207], v[172:175], v[60:63], v[204:207]
    ds_read_b128 v[72:75], v8 offset:35072
    v_mfma_f32_16x16x32_bf16 v[208:211], v[176:179], v[60:63], v[208:211]
    ds_read_b64_tr_b16 v[56:57], v22 offset:8192
    s_waitcnt lgkmcnt(11)
    v_mfma_f32_16x16x32_bf16 v[212:215], v[168:171], v[32:35], v[212:215]
    ds_read_b64_tr_b16 v[58:59], v22 offset:8704
    s_add_u32 m0, s41, 118784
    s_bfe_u32 s49, 0x52423222, s92
    v_mfma_f32_16x16x32_bf16 v[216:219], v[172:175], v[32:35], v[216:219]
    ds_read_b64_tr_b16 v[40:41], v23 offset:8192
    s_xor_b32 s49, s49, s95
    s_lshl_b32 s49, s49, 14
    v_mfma_f32_16x16x32_bf16 v[220:223], v[176:179], v[32:35], v[220:223]
    ds_read_b64_tr_b16 v[42:43], v23 offset:8704
    buffer_load_dwordx4 v4, s[24:27], s49 offen offset:0 lds
    v_mfma_f32_16x16x32_bf16 v[224:227], v[180:183], v[32:35], v[224:227]
    ds_read_b128 a[40:43], v17 offset:17664
    v_mfma_f32_16x16x32_bf16 v[196:199], v[168:171], v[48:51], v[196:199]
    ds_read_b128 a[44:47], v18 offset:17408
    v_mfma_f32_16x16x32_bf16 v[200:203], v[172:175], v[48:51], v[200:203]
    ds_read_b128 v[76:79], v9 offset:35072
    v_mfma_f32_16x16x32_bf16 v[204:207], v[176:179], v[48:51], v[204:207]
    ds_read_b128 v[80:83], v10 offset:34816
    v_mfma_f32_16x16x32_bf16 v[208:211], v[180:183], v[48:51], v[208:211]
    buffer_load_dwordx4 v5, s[24:27], s49 offen offset:1024 lds
    s_waitcnt lgkmcnt(11)
    v_mfma_f32_16x16x32_bf16 v[212:215], v[172:175], v[36:39], v[212:215]
    ds_read_b64_tr_b16 v[60:61], v22 offset:12288
    v_mfma_f32_16x16x32_bf16 v[216:219], v[176:179], v[36:39], v[216:219]
    ds_read_b64_tr_b16 v[62:63], v22 offset:12800
    v_mfma_f32_16x16x32_bf16 v[220:223], v[180:183], v[36:39], v[220:223]
    ds_read_b64_tr_b16 v[44:45], v23 offset:12288
    v_mfma_f32_16x16x32_bf16 v[224:227], v[184:187], v[36:39], v[224:227]
    ds_read_b64_tr_b16 v[46:47], v23 offset:12800
    v_mfma_f32_16x16x32_bf16 v[196:199], v[172:175], v[52:55], v[196:199]
    ds_read_b128 a[48:51], v19 offset:17408
    v_mfma_f32_16x16x32_bf16 v[200:203], v[176:179], v[52:55], v[200:203]
    ds_read_b128 v[84:87], v11 offset:34816
    v_mfma_f32_16x16x32_bf16 v[204:207], v[180:183], v[52:55], v[204:207]
    buffer_load_dwordx4 v6, s[24:27], s49 offen offset:2048 lds
    v_mfma_f32_16x16x32_bf16 v[208:211], v[184:187], v[52:55], v[208:211]
    s_waitcnt vmcnt(13)
    s_barrier
    s_waitcnt lgkmcnt(10)
    v_mfma_f32_16x16x32_bf16 v[212:215], v[176:179], v[40:43], v[212:215]
    ds_read_b64_tr_b16 v[48:49], v22 offset:16384
    buffer_load_dwordx4 v7, s[24:27], s49 offen offset:3072 lds
    v_mfma_f32_16x16x32_bf16 v[216:219], v[180:183], v[40:43], v[216:219]
    ds_read_b64_tr_b16 v[50:51], v22 offset:16896
    s_add_u32 m0, s41, 135168
    s_bfe_u32 s49, 0x13037262, s92
    v_mfma_f32_16x16x32_bf16 v[220:223], v[184:187], v[40:43], v[220:223]
    ds_read_b64_tr_b16 v[32:33], v23 offset:16384
    v_mfma_f32_16x16x32_bf16 v[224:227], v[188:191], v[40:43], v[224:227]
    ds_read_b64_tr_b16 v[34:35], v23 offset:16896
    v_mfma_f32_16x16x32_bf16 v[196:199], v[176:179], v[56:59], v[196:199]
    ds_read_b128 v[88:91], v10 offset:35072
    v_mfma_f32_16x16x32_bf16 v[200:203], v[180:183], v[56:59], v[200:203]
    s_xor_b32 s49, s49, s95
    s_lshl_b32 s49, s49, 14
    v_mfma_f32_16x16x32_bf16 v[204:207], v[184:187], v[56:59], v[204:207]
    buffer_load_dwordx4 v4, s[24:27], s49 offen offset:0 lds
    v_mfma_f32_16x16x32_bf16 v[208:211], v[188:191], v[56:59], v[208:211]
    buffer_load_dwordx4 v5, s[24:27], s49 offen offset:1024 lds
    s_waitcnt lgkmcnt(7)
    v_mfma_f32_16x16x32_bf16 v[212:215], a[12:15], v[44:47], v[212:215]
    ds_read_b64_tr_b16 v[52:53], v22 offset:20480
    buffer_load_dwordx4 v6, s[24:27], s49 offen offset:2048 lds
    v_mfma_f32_16x16x32_bf16 v[216:219], a[16:19], v[44:47], v[216:219]
    ds_read_b64_tr_b16 v[54:55], v22 offset:20992
    v_mfma_f32_16x16x32_bf16 v[220:223], a[20:23], v[44:47], v[220:223]
    ds_read_b64_tr_b16 v[36:37], v23 offset:20480
    v_mfma_f32_16x16x32_bf16 v[224:227], a[24:27], v[44:47], v[224:227]
    ds_read_b64_tr_b16 v[38:39], v23 offset:20992
    v_mfma_f32_16x16x32_bf16 v[196:199], a[12:15], v[60:63], v[196:199]
    ds_read_b128 v[92:95], v11 offset:35072
    v_mfma_f32_16x16x32_bf16 v[200:203], a[16:19], v[60:63], v[200:203]
    ds_read_b128 v[96:99], v12 offset:34816
    v_mfma_f32_16x16x32_bf16 v[204:207], a[20:23], v[60:63], v[204:207]
    buffer_store_dwordx4 a[0:3], v234, s[32:35], 0 offen offset:1024 sc0 sc1
    v_mfma_f32_16x16x32_bf16 v[208:211], a[24:27], v[60:63], v[208:211]
    s_waitcnt lgkmcnt(7)
    v_mfma_f32_16x16x32_bf16 v[212:215], a[16:19], v[32:35], v[212:215]
    ds_read_b64_tr_b16 v[56:57], v22 offset:24576
    v_mfma_f32_16x16x32_bf16 v[216:219], a[20:23], v[32:35], v[216:219]
    ds_read_b64_tr_b16 v[58:59], v22 offset:25088
    v_mfma_f32_16x16x32_bf16 v[220:223], a[24:27], v[32:35], v[220:223]
    ds_read_b64_tr_b16 v[40:41], v23 offset:24576
    v_mfma_f32_16x16x32_bf16 v[224:227], a[28:31], v[32:35], v[224:227]
    ds_read_b64_tr_b16 v[42:43], v23 offset:25088
    v_mfma_f32_16x16x32_bf16 v[196:199], a[16:19], v[48:51], v[196:199]
    ds_read_b128 v[100:103], v13 offset:34816
    v_mfma_f32_16x16x32_bf16 v[200:203], a[20:23], v[48:51], v[200:203]
    buffer_load_dwordx4 v7, s[24:27], s49 offen offset:3072 lds
    v_mfma_f32_16x16x32_bf16 v[204:207], a[24:27], v[48:51], v[204:207]
    v_mfma_f32_16x16x32_bf16 v[208:211], a[28:31], v[48:51], v[208:211]
    s_waitcnt lgkmcnt(7)
    v_mfma_f32_16x16x32_bf16 v[212:215], a[20:23], v[36:39], v[212:215]
    ds_read_b64_tr_b16 v[60:61], v22 offset:28672
    v_mfma_f32_16x16x32_bf16 v[216:219], a[24:27], v[36:39], v[216:219]
    ds_read_b64_tr_b16 v[62:63], v22 offset:29184
    v_mfma_f32_16x16x32_bf16 v[220:223], a[28:31], v[36:39], v[220:223]
    ds_read_b64_tr_b16 v[44:45], v23 offset:28672
    v_mfma_f32_16x16x32_bf16 v[224:227], a[32:35], v[36:39], v[224:227]
    ds_read_b64_tr_b16 v[46:47], v23 offset:29184
    v_mfma_f32_16x16x32_bf16 v[196:199], a[20:23], v[52:55], v[196:199]
    ds_read_b128 v[104:107], v12 offset:35072
    v_mfma_f32_16x16x32_bf16 v[200:203], a[24:27], v[52:55], v[200:203]
    v_mfma_f32_16x16x32_bf16 v[204:207], a[28:31], v[52:55], v[204:207]
    v_mfma_f32_16x16x32_bf16 v[208:211], a[32:35], v[52:55], v[208:211]
    s_waitcnt vmcnt(5)
    s_barrier
    s_waitcnt lgkmcnt(6)
    v_mfma_f32_16x16x32_bf16 v[212:215], a[24:27], v[40:43], v[212:215]
    ds_read_b64_tr_b16 v[48:49], v22 offset:32768
    s_add_u32 m0, s41, 69632
    s_bfe_u32 s49, 0x53433323, s92
    v_mfma_f32_16x16x32_bf16 v[216:219], a[28:31], v[40:43], v[216:219]
    ds_read_b64_tr_b16 v[50:51], v22 offset:33280
    s_xor_b32 s49, s49, s95
    s_lshl_b32 s49, s49, 14
    v_mfma_f32_16x16x32_bf16 v[220:223], a[32:35], v[40:43], v[220:223]
    ds_read_b64_tr_b16 v[32:33], v23 offset:32768
    buffer_load_dwordx4 v4, s[24:27], s49 offen offset:0 lds
    v_mfma_f32_16x16x32_bf16 v[224:227], a[36:39], v[40:43], v[224:227]
    ds_read_b64_tr_b16 v[34:35], v23 offset:33280
    v_mfma_f32_16x16x32_bf16 v[196:199], a[24:27], v[56:59], v[196:199]
    ds_read_b128 v[108:111], v14 offset:34816
    v_mfma_f32_16x16x32_bf16 v[200:203], a[28:31], v[56:59], v[200:203]
    ds_read_b128 v[112:115], v15 offset:34816
    v_mfma_f32_16x16x32_bf16 v[204:207], a[32:35], v[56:59], v[204:207]
    buffer_load_dwordx4 v5, s[24:27], s49 offen offset:1024 lds
    v_mfma_f32_16x16x32_bf16 v[208:211], a[36:39], v[56:59], v[208:211]
    buffer_load_dwordx4 v6, s[24:27], s49 offen offset:2048 lds
    s_waitcnt lgkmcnt(7)
    v_mfma_f32_16x16x32_bf16 v[212:215], a[28:31], v[44:47], v[212:215]
    ds_read_b64_tr_b16 v[52:53], v22 offset:36864
    v_mfma_f32_16x16x32_bf16 v[216:219], a[32:35], v[44:47], v[216:219]
    ds_read_b64_tr_b16 v[54:55], v22 offset:37376
    v_mfma_f32_16x16x32_bf16 v[220:223], a[36:39], v[44:47], v[220:223]
    ds_read_b64_tr_b16 v[36:37], v23 offset:36864
    v_mfma_f32_16x16x32_bf16 v[224:227], a[40:43], v[44:47], v[224:227]
    ds_read_b64_tr_b16 v[38:39], v23 offset:37376
    v_mfma_f32_16x16x32_bf16 v[196:199], a[28:31], v[60:63], v[196:199]
    ds_read_b128 v[116:119], v14 offset:35072
    v_mfma_f32_16x16x32_bf16 v[200:203], a[32:35], v[60:63], v[200:203]
    buffer_load_dwordx4 v7, s[24:27], s49 offen offset:3072 lds
    v_mfma_f32_16x16x32_bf16 v[204:207], a[36:39], v[60:63], v[204:207]
    buffer_store_dword a0, v233, s[32:35], 0 offen sc0 sc1
    v_mfma_f32_16x16x32_bf16 v[208:211], a[40:43], v[60:63], v[208:211]
    s_add_u32 m0, s41, 0
    s_bfe_u32 s49, 0x1a0a7363, s92
    s_waitcnt lgkmcnt(7)
    v_mfma_f32_16x16x32_bf16 v[212:215], a[32:35], v[32:35], v[212:215]
    ds_read_b64_tr_b16 a[4:5], v22 offset:40960
    v_mfma_f32_16x16x32_bf16 v[216:219], a[36:39], v[32:35], v[216:219]
    ds_read_b64_tr_b16 a[6:7], v22 offset:41472
    v_mfma_f32_16x16x32_bf16 v[220:223], a[40:43], v[32:35], v[220:223]
    ds_read_b64_tr_b16 v[40:41], v23 offset:40960
    v_mfma_f32_16x16x32_bf16 v[224:227], a[44:47], v[32:35], v[224:227]
    ds_read_b64_tr_b16 v[42:43], v23 offset:41472
    v_mfma_f32_16x16x32_bf16 v[196:199], a[32:35], v[48:51], v[196:199]
    ds_read_b128 v[120:123], v15 offset:35072
    v_mfma_f32_16x16x32_bf16 v[200:203], a[36:39], v[48:51], v[200:203]
    s_xor_b32 s49, s49, s95
    s_lshl_b32 s49, s49, 14
    v_mfma_f32_16x16x32_bf16 v[204:207], a[40:43], v[48:51], v[204:207]
    buffer_load_dwordx4 v4, s[24:27], s49 offen offset:0 lds
    v_mfma_f32_16x16x32_bf16 v[208:211], a[44:47], v[48:51], v[208:211]
    buffer_load_dwordx4 v5, s[24:27], s49 offen offset:1024 lds
    s_waitcnt lgkmcnt(6)
    v_mfma_f32_16x16x32_bf16 v[212:215], a[36:39], v[36:39], v[212:215]
    ds_read_b64_tr_b16 a[8:9], v22 offset:45056
    buffer_load_dwordx4 v6, s[24:27], s49 offen offset:2048 lds
    v_mfma_f32_16x16x32_bf16 v[216:219], a[40:43], v[36:39], v[216:219]
    ds_read_b64_tr_b16 a[10:11], v22 offset:45568
    v_mfma_f32_16x16x32_bf16 v[220:223], a[44:47], v[36:39], v[220:223]
    ds_read_b64_tr_b16 v[44:45], v23 offset:45056
    v_mfma_f32_16x16x32_bf16 v[224:227], a[48:51], v[36:39], v[224:227]
    ds_read_b64_tr_b16 v[46:47], v23 offset:45568
    v_mfma_f32_16x16x32_bf16 v[196:199], a[36:39], v[52:55], v[196:199]
    ds_read_b64_tr_b16 v[32:33], v23 offset:49152
    v_mfma_f32_16x16x32_bf16 v[200:203], a[40:43], v[52:55], v[200:203]
    ds_read_b64_tr_b16 v[34:35], v23 offset:49664
    v_mfma_f32_16x16x32_bf16 v[204:207], a[44:47], v[52:55], v[204:207]
    ds_read_b128 v[124:127], v16 offset:34816
    v_mfma_f32_16x16x32_bf16 v[208:211], a[48:51], v[52:55], v[208:211]
    ds_read_b64_tr_b16 v[36:37], v23 offset:53248
    buffer_load_dwordx4 v7, s[24:27], s49 offen offset:3072 lds
    s_waitcnt lgkmcnt(9)
    v_mfma_f32_16x16x32_bf16 v[212:215], v[64:67], v[40:43], v[212:215]
    ds_read_b64_tr_b16 v[38:39], v23 offset:53760
    s_add_u32 m0, s41, 16384
    s_bfe_u32 s49, 0x5a4a3a2a, s92
    v_mfma_f32_16x16x32_bf16 v[216:219], v[68:71], v[40:43], v[216:219]
    ds_read_b128 v[128:131], v17 offset:34816
    s_xor_b32 s49, s49, s95
    s_lshl_b32 s49, s49, 14
    v_mfma_f32_16x16x32_bf16 v[220:223], v[72:75], v[40:43], v[220:223]
    ds_read_b128 v[152:155], v8 offset:52224
    buffer_load_dwordx4 v4, s[24:27], s49 offen offset:0 lds
    v_mfma_f32_16x16x32_bf16 v[224:227], v[76:79], v[40:43], v[224:227]
    ds_read_b64_tr_b16 v[40:41], v23 offset:57344
    s_waitcnt lgkmcnt(8)
    v_mfma_f32_16x16x32_bf16 v[212:215], v[68:71], v[44:47], v[212:215]
    ds_read_b64_tr_b16 v[42:43], v23 offset:57856
    buffer_load_dwordx4 v5, s[24:27], s49 offen offset:1024 lds
    v_mfma_f32_16x16x32_bf16 v[216:219], v[72:75], v[44:47], v[216:219]
    ds_read_b128 v[132:135], v16 offset:35072
    v_mfma_f32_16x16x32_bf16 v[220:223], v[76:79], v[44:47], v[220:223]
    ds_read_b128 v[156:159], v9 offset:52224
    v_mfma_f32_16x16x32_bf16 v[224:227], v[80:83], v[44:47], v[224:227]
    ds_read_b64_tr_b16 v[44:45], v23 offset:61440
    s_waitcnt lgkmcnt(10)
    v_mfma_f32_16x16x32_bf16 v[212:215], v[72:75], v[32:35], v[212:215]
    ds_read_b64_tr_b16 v[46:47], v23 offset:61952
    buffer_load_dwordx4 v6, s[24:27], s49 offen offset:2048 lds
    v_mfma_f32_16x16x32_bf16 v[216:219], v[76:79], v[32:35], v[216:219]
    ds_read_b128 v[136:139], v17 offset:35072
    buffer_load_dwordx4 v7, s[24:27], s49 offen offset:3072 lds
    v_mfma_f32_16x16x32_bf16 v[220:223], v[80:83], v[32:35], v[220:223]
    ds_read_b128 v[160:163], v8 offset:52480
    v_mfma_f32_16x16x32_bf16 v[224:227], v[84:87], v[32:35], v[224:227]
    s_waitcnt vmcnt(8)
    s_barrier
    s_waitcnt lgkmcnt(10)
    v_mfma_f32_16x16x32_bf16 v[212:215], v[76:79], v[36:39], v[212:215]
    ds_read_b64_tr_b16 v[32:33], v25 offset:0
    s_add_u32 m0, s41, 86016
    s_bfe_u32 s49, 0x2b1b0b6a, s92
    v_mfma_f32_16x16x32_bf16 v[216:219], v[80:83], v[36:39], v[216:219]
    ds_read_b64_tr_b16 v[34:35], v25 offset:512
    s_xor_b32 s49, s49, s95
    s_lshl_b32 s49, s49, 14
    v_mfma_f32_16x16x32_bf16 v[220:223], v[84:87], v[36:39], v[220:223]
    ds_read_b128 v[140:143], v18 offset:34816
    buffer_load_dwordx4 v4, s[24:27], s49 offen offset:0 lds
    v_mfma_f32_16x16x32_bf16 v[224:227], v[88:91], v[36:39], v[224:227]
    ds_read_b64_tr_b16 v[36:37], v25 offset:4096
    s_waitcnt lgkmcnt(10)
    v_mfma_f32_16x16x32_bf16 v[212:215], v[80:83], v[40:43], v[212:215]
    ds_read_b64_tr_b16 v[38:39], v25 offset:4608
    buffer_load_dwordx4 v5, s[24:27], s49 offen offset:1024 lds
    v_mfma_f32_16x16x32_bf16 v[216:219], v[84:87], v[40:43], v[216:219]
    ds_read_b128 v[144:147], v19 offset:34816
    buffer_load_dwordx4 v6, s[24:27], s49 offen offset:2048 lds
    v_mfma_f32_16x16x32_bf16 v[220:223], v[88:91], v[40:43], v[220:223]
    ds_read_b128 v[164:167], v9 offset:52480
    v_mfma_f32_16x16x32_bf16 v[224:227], v[92:95], v[40:43], v[224:227]
    ds_read_b64_tr_b16 v[40:41], v25 offset:8192
    s_waitcnt lgkmcnt(10)
    v_mfma_f32_16x16x32_bf16 v[212:215], v[84:87], v[44:47], v[212:215]
    ds_read_b64_tr_b16 v[42:43], v25 offset:8704
    buffer_load_dwordx4 v7, s[24:27], s49 offen offset:3072 lds
    v_mfma_f32_16x16x32_bf16 v[216:219], v[88:91], v[44:47], v[216:219]
    ds_read_b128 v[148:151], v18 offset:35072
    v_mfma_f32_16x16x32_bf16 v[220:223], v[92:95], v[44:47], v[220:223]
    ds_read_b128 v[168:171], v10 offset:52224
    v_mfma_f32_16x16x32_bf16 v[224:227], v[96:99], v[44:47], v[224:227]
    s_add_u32 m0, s41, 102400
    s_bfe_u32 s49, 0x6b5b4b3b, s92
    s_waitcnt lgkmcnt(9)
    v_mfma_f32_16x16x32_bf16 v[212:215], v[88:91], v[32:35], v[212:215]
    ds_read_b64_tr_b16 v[44:45], v25 offset:12288
    s_xor_b32 s49, s49, s95
    s_lshl_b32 s49, s49, 14
    v_mfma_f32_16x16x32_bf16 v[216:219], v[92:95], v[32:35], v[216:219]
    ds_read_b64_tr_b16 v[46:47], v25 offset:12800
    buffer_load_dwordx4 v4, s[24:27], s49 offen offset:0 lds
    v_mfma_f32_16x16x32_bf16 v[220:223], v[96:99], v[32:35], v[220:223]
    ds_read_b128 a[56:59], v14 offset:52224
    buffer_load_dwordx4 v5, s[24:27], s49 offen offset:1024 lds
    v_mfma_f32_16x16x32_bf16 v[224:227], v[100:103], v[32:35], v[224:227]
    ds_read_b64_tr_b16 v[32:33], v23 offset:0
    s_waitcnt lgkmcnt(10)
    v_mfma_f32_16x16x32_bf16 v[212:215], v[92:95], v[36:39], v[212:215]
    ds_read_b64_tr_b16 v[34:35], v23 offset:512
    buffer_load_dwordx4 v6, s[24:27], s49 offen offset:2048 lds
    v_mfma_f32_16x16x32_bf16 v[216:219], v[96:99], v[36:39], v[216:219]
    ds_read_b128 v[172:175], v11 offset:52224
    v_mfma_f32_16x16x32_bf16 v[220:223], v[100:103], v[36:39], v[220:223]
    ds_read_b128 a[60:63], v15 offset:52224
    v_mfma_f32_16x16x32_bf16 v[224:227], v[104:107], v[36:39], v[224:227]
    buffer_load_dwordx4 v7, s[24:27], s49 offen offset:3072 lds
    s_waitcnt lgkmcnt(9)
    v_mfma_f32_16x16x32_bf16 v[212:215], v[108:111], v[40:43], v[212:215]
    ds_read_b64_tr_b16 v[36:37], v23 offset:4096
    v_mfma_f32_16x16x32_bf16 v[216:219], v[112:115], v[40:43], v[216:219]
    ds_read_b64_tr_b16 v[38:39], v23 offset:4608
    v_mfma_f32_16x16x32_bf16 v[220:223], v[116:119], v[40:43], v[220:223]
    ds_read_b128 v[176:179], v10 offset:52480
    v_mfma_f32_16x16x32_bf16 v[224:227], v[120:123], v[40:43], v[224:227]
    ds_read_b64_tr_b16 v[40:41], v23 offset:8192
    s_waitcnt lgkmcnt(9)
    v_mfma_f32_16x16x32_bf16 v[212:215], v[112:115], v[44:47], v[212:215]
    ds_read_b64_tr_b16 v[42:43], v23 offset:8704
    s_cmp_lg_u32 s40, 0
    s_cbranch_scc1 L_nosig0
    s_mov_b64 exec, 1
    buffer_atomic_add_x2 v[250:251], v236, s[36:39], 0 offen sc1
    s_mov_b64 exec, -1
    s_branch L_sigd0
L_nosig0:
    buffer_load_dword v26, v4, s[24:27], 0 offen
L_sigd0:
    v_mfma_f32_16x16x32_bf16 v[216:219], v[116:119], v[44:47], v[216:219]
    ds_read_b128 v[180:183], v11 offset:52480
    v_mfma_f32_16x16x32_bf16 v[220:223], v[120:123], v[44:47], v[220:223]
    ds_read_b128 a[64:67], v14 offset:52480
    v_mfma_f32_16x16x32_bf16 v[224:227], v[124:127], v[44:47], v[224:227]
    s_waitcnt lgkmcnt(9)
    v_mfma_f32_16x16x32_bf16 v[212:215], v[116:119], v[32:35], v[212:215]
    ds_read_b64_tr_b16 v[44:45], v23 offset:12288
    v_mfma_f32_16x16x32_bf16 v[216:219], v[120:123], v[32:35], v[216:219]
    ds_read_b64_tr_b16 v[46:47], v23 offset:12800
    v_mfma_f32_16x16x32_bf16 v[220:223], v[124:127], v[32:35], v[220:223]
    ds_read_b128 a[68:71], v15 offset:52480
    v_mfma_f32_16x16x32_bf16 v[224:227], v[128:131], v[32:35], v[224:227]
    s_waitcnt vmcnt(9)
    s_barrier
    s_waitcnt lgkmcnt(8)
    v_mfma_f32_16x16x32_bf16 v[212:215], v[120:123], v[36:39], v[212:215]
    ds_read_b64_tr_b16 v[32:33], v21 offset:0
    v_mfma_f32_16x16x32_bf16 v[216:219], v[124:127], v[36:39], v[216:219]
    ds_read_b64_tr_b16 v[34:35], v21 offset:512
    v_mfma_f32_16x16x32_bf16 v[220:223], v[128:131], v[36:39], v[220:223]
    ds_read_b128 v[184:187], v12 offset:52224
    v_mfma_f32_16x16x32_bf16 v[224:227], v[132:135], v[36:39], v[224:227]
    ds_read_b64_tr_b16 v[36:37], v21 offset:4096
    s_waitcnt lgkmcnt(9)
    v_mfma_f32_16x16x32_bf16 v[212:215], v[124:127], v[40:43], v[212:215]
    ds_read_b64_tr_b16 v[38:39], v21 offset:4608
    v_mfma_f32_16x16x32_bf16 v[216:219], v[128:131], v[40:43], v[216:219]
    ds_read_b128 v[188:191], v13 offset:52224
    v_mfma_f32_16x16x32_bf16 v[220:223], v[132:135], v[40:43], v[220:223]
    ds_read_b128 a[72:75], v16 offset:52224
    v_mfma_f32_16x16x32_bf16 v[224:227], v[136:139], v[40:43], v[224:227]
    s_waitcnt lgkmcnt(8)
    v_mfma_f32_16x16x32_bf16 v[212:215], v[128:131], v[44:47], v[212:215]
    ds_read_b64_tr_b16 v[40:41], v21 offset:8192
    v_mfma_f32_16x16x32_bf16 v[216:219], v[132:135], v[44:47], v[216:219]
    ds_read_b64_tr_b16 v[42:43], v21 offset:8704
    v_mfma_f32_16x16x32_bf16 v[220:223], v[136:139], v[44:47], v[220:223]
    v_mfma_f32_16x16x32_bf16 v[224:227], v[140:143], v[44:47], v[224:227]
    s_waitcnt lgkmcnt(7)
    v_mfma_f32_16x16x32_bf16 v[212:215], v[132:135], v[32:35], v[212:215]
    ds_read_b64_tr_b16 v[44:45], v21 offset:12288
    v_mfma_f32_16x16x32_bf16 v[216:219], v[136:139], v[32:35], v[216:219]
    ds_read_b64_tr_b16 v[46:47], v21 offset:12800
    v_mfma_f32_16x16x32_bf16 v[220:223], v[140:143], v[32:35], v[220:223]
    ds_read_b128 a[76:79], v17 offset:52224
    v_mfma_f32_16x16x32_bf16 v[224:227], v[144:147], v[32:35], v[224:227]
    s_waitcnt lgkmcnt(7)
    v_mfma_f32_16x16x32_bf16 v[212:215], v[136:139], v[36:39], v[212:215]
    ds_read_b64_tr_b16 v[32:33], v21 offset:16384
    v_mfma_f32_16x16x32_bf16 v[216:219], v[140:143], v[36:39], v[216:219]
    ds_read_b64_tr_b16 v[34:35], v21 offset:16896
    v_mfma_f32_16x16x32_bf16 v[220:223], v[144:147], v[36:39], v[220:223]
    ds_read_b128 a[80:83], v16 offset:52480
    v_mfma_f32_16x16x32_bf16 v[224:227], v[148:151], v[36:39], v[224:227]
    s_waitcnt lgkmcnt(6)
    v_mfma_f32_16x16x32_bf16 v[212:215], v[152:155], v[40:43], v[212:215]
    ds_read_b64_tr_b16 v[36:37], v21 offset:20480
    v_mfma_f32_16x16x32_bf16 v[216:219], v[156:159], v[40:43], v[216:219]
    ds_read_b64_tr_b16 v[38:39], v21 offset:20992
    v_mfma_f32_16x16x32_bf16 v[220:223], v[160:163], v[40:43], v[220:223]
    v_mfma_f32_16x16x32_bf16 v[224:227], v[164:167], v[40:43], v[224:227]
    s_waitcnt lgkmcnt(6)
    v_mfma_f32_16x16x32_bf16 v[212:215], v[156:159], v[44:47], v[212:215]
    ds_read_b64_tr_b16 v[40:41], v21 offset:24576
    v_mfma_f32_16x16x32_bf16 v[216:219], v[160:163], v[44:47], v[216:219]
    ds_read_b64_tr_b16 v[42:43], v21 offset:25088
    v_mfma_f32_16x16x32_bf16 v[220:223], v[164:167], v[44:47], v[220:223]
    ds_read_b128 a[84:87], v17 offset:52480
    v_mfma_f32_16x16x32_bf16 v[224:227], v[168:171], v[44:47], v[224:227]
    s_waitcnt lgkmcnt(6)
    v_mfma_f32_16x16x32_bf16 v[212:215], v[160:163], v[32:35], v[212:215]
    ds_read_b64_tr_b16 v[44:45], v21 offset:28672
    v_mfma_f32_16x16x32_bf16 v[216:219], v[164:167], v[32:35], v[216:219]
    ds_read_b64_tr_b16 v[46:47], v21 offset:29184
    v_mfma_f32_16x16x32_bf16 v[220:223], v[168:171], v[32:35], v[220:223]
    ds_read_b128 a[88:91], v18 offset:52224
    v_mfma_f32_16x16x32_bf16 v[224:227], v[172:175], v[32:35], v[224:227]
    s_waitcnt vmcnt(1)
    s_barrier
    s_waitcnt lgkmcnt(6)
    v_mfma_f32_16x16x32_bf16 v[212:215], v[164:167], v[36:39], v[212:215]
    ds_read_b64_tr_b16 v[32:33], v23 offset:16384
    v_mfma_f32_16x16x32_bf16 v[216:219], v[168:171], v[36:39], v[216:219]
    ds_read_b64_tr_b16 v[34:35], v23 offset:16896
    v_mfma_f32_16x16x32_bf16 v[220:223], v[172:175], v[36:39], v[220:223]
    v_mfma_f32_16x16x32_bf16 v[224:227], v[176:179], v[36:39], v[224:227]
    s_waitcnt lgkmcnt(6)
    v_mfma_f32_16x16x32_bf16 v[212:215], v[168:171], v[40:43], v[212:215]
    ds_read_b64_tr_b16 v[36:37], v23 offset:20480
    v_mfma_f32_16x16x32_bf16 v[216:219], v[172:175], v[40:43], v[216:219]
    ds_read_b64_tr_b16 v[38:39], v23 offset:20992
    v_mfma_f32_16x16x32_bf16 v[220:223], v[176:179], v[40:43], v[220:223]
    ds_read_b128 a[92:95], v19 offset:52224
    v_mfma_f32_16x16x32_bf16 v[224:227], v[180:183], v[40:43], v[224:227]
    s_waitcnt lgkmcnt(6)
    v_mfma_f32_16x16x32_bf16 v[212:215], v[172:175], v[44:47], v[212:215]
    ds_read_b64_tr_b16 v[40:41], v23 offset:24576
    v_mfma_f32_16x16x32_bf16 v[216:219], v[176:179], v[44:47], v[216:219]
    ds_read_b64_tr_b16 v[42:43], v23 offset:25088
    v_mfma_f32_16x16x32_bf16 v[220:223], v[180:183], v[44:47], v[220:223]
    v_mfma_f32_16x16x32_bf16 v[224:227], v[184:187], v[44:47], v[224:227]
    s_waitcnt lgkmcnt(5)
    v_mfma_f32_16x16x32_bf16 v[212:215], v[176:179], v[32:35], v[212:215]
    ds_read_b64_tr_b16 v[44:45], v23 offset:28672
    v_mfma_f32_16x16x32_bf16 v[216:219], v[180:183], v[32:35], v[216:219]
    ds_read_b64_tr_b16 v[46:47], v23 offset:29184
    v_mfma_f32_16x16x32_bf16 v[220:223], v[184:187], v[32:35], v[220:223]
    v_mfma_f32_16x16x32_bf16 v[224:227], v[188:191], v[32:35], v[224:227]
    s_waitcnt lgkmcnt(5)
    v_mfma_f32_16x16x32_bf16 v[212:215], a[56:59], v[36:39], v[212:215]
    ds_read_b64_tr_b16 v[32:33], v23 offset:32768
    v_mfma_f32_16x16x32_bf16 v[216:219], a[60:63], v[36:39], v[216:219]
    ds_read_b64_tr_b16 v[34:35], v23 offset:33280
    v_mfma_f32_16x16x32_bf16 v[220:223], a[64:67], v[36:39], v[220:223]
    v_mfma_f32_16x16x32_bf16 v[224:227], a[68:71], v[36:39], v[224:227]
    s_waitcnt lgkmcnt(4)
    v_mfma_f32_16x16x32_bf16 v[212:215], a[60:63], v[40:43], v[212:215]
    ds_read_b64_tr_b16 v[36:37], v23 offset:36864
    v_mfma_f32_16x16x32_bf16 v[216:219], a[64:67], v[40:43], v[216:219]
    ds_read_b64_tr_b16 v[38:39], v23 offset:37376
    v_mfma_f32_16x16x32_bf16 v[220:223], a[68:71], v[40:43], v[220:223]
    v_mfma_f32_16x16x32_bf16 v[224:227], a[72:75], v[40:43], v[224:227]
    s_waitcnt lgkmcnt(4)
    v_mfma_f32_16x16x32_bf16 v[212:215], a[64:67], v[44:47], v[212:215]
    ds_read_b64_tr_b16 v[40:41], v23 offset:40960
    v_mfma_f32_16x16x32_bf16 v[216:219], a[68:71], v[44:47], v[216:219]
    ds_read_b64_tr_b16 v[42:43], v23 offset:41472
    v_mfma_f32_16x16x32_bf16 v[220:223], a[72:75], v[44:47], v[220:223]
    v_mfma_f32_16x16x32_bf16 v[224:227], a[76:79], v[44:47], v[224:227]
    s_waitcnt lgkmcnt(4)
    v_mfma_f32_16x16x32_bf16 v[212:215], a[68:71], v[32:35], v[212:215]
    ds_read_b64_tr_b16 v[44:45], v23 offset:45056
    v_mfma_f32_16x16x32_bf16 v[216:219], a[72:75], v[32:35], v[216:219]
    ds_read_b64_tr_b16 v[46:47], v23 offset:45568
    v_mfma_f32_16x16x32_bf16 v[220:223], a[76:79], v[32:35], v[220:223]
    v_mfma_f32_16x16x32_bf16 v[224:227], a[80:83], v[32:35], v[224:227]
    s_waitcnt lgkmcnt(4)
    v_mfma_f32_16x16x32_bf16 v[212:215], a[72:75], v[36:39], v[212:215]
    v_mfma_f32_16x16x32_bf16 v[216:219], a[76:79], v[36:39], v[216:219]
    v_mfma_f32_16x16x32_bf16 v[220:223], a[80:83], v[36:39], v[220:223]
    v_mfma_f32_16x16x32_bf16 v[224:227], a[84:87], v[36:39], v[224:227]
    s_waitcnt lgkmcnt(2)
    v_mfma_f32_16x16x32_bf16 v[212:215], a[76:79], v[40:43], v[212:215]
    v_mfma_f32_16x16x32_bf16 v[216:219], a[80:83], v[40:43], v[216:219]
    v_mfma_f32_16x16x32_bf16 v[220:223], a[84:87], v[40:43], v[220:223]
    v_mfma_f32_16x16x32_bf16 v[224:227], a[88:91], v[40:43], v[224:227]
    s_waitcnt lgkmcnt(0)
    v_mfma_f32_16x16x32_bf16 v[212:215], a[80:83], v[44:47], v[212:215]
    v_mfma_f32_16x16x32_bf16 v[216:219], a[84:87], v[44:47], v[216:219]
    v_mfma_f32_16x16x32_bf16 v[220:223], a[88:91], v[44:47], v[220:223]
    v_mfma_f32_16x16x32_bf16 v[224:227], a[92:95], v[44:47], v[224:227]
    ds_read_b64_tr_b16 v[48:49], v22 offset:49152
    ds_read_b64_tr_b16 v[50:51], v22 offset:49664
    v_mfma_f32_16x16x32_bf16 v[196:199], v[64:67], a[4:7], v[196:199]
    ds_read_b64_tr_b16 v[52:53], v22 offset:53248
    v_mfma_f32_16x16x32_bf16 v[200:203], v[68:71], a[4:7], v[200:203]
    v_mfma_f32_16x16x32_bf16 v[204:207], v[72:75], a[4:7], v[204:207]
    ds_read_b64_tr_b16 v[54:55], v22 offset:53760
    v_mfma_f32_16x16x32_bf16 v[208:211], v[76:79], a[4:7], v[208:211]
    v_mfma_f32_16x16x32_bf16 v[196:199], v[68:71], a[8:11], v[196:199]
    ds_read_b64_tr_b16 v[56:57], v22 offset:57344
    v_cvt_pk_bf16_f32 v32, v212, v213
    v_mfma_f32_16x16x32_bf16 v[200:203], v[72:75], a[8:11], v[200:203]
    v_min_u32 v32, 0xfffffffe, v32
    v_cvt_pk_bf16_f32 v33, v214, v215
    v_mfma_f32_16x16x32_bf16 v[204:207], v[76:79], a[8:11], v[204:207]
    ds_read_b64_tr_b16 v[58:59], v22 offset:57856
    v_min_u32 v33, 0xfffffffe, v33
    v_cvt_pk_bf16_f32 v34, v216, v217
    v_mfma_f32_16x16x32_bf16 v[208:211], v[80:83], a[8:11], v[208:211]
    v_min_u32 v34, 0xfffffffe, v34
    v_cvt_pk_bf16_f32 v35, v218, v219
    s_waitcnt lgkmcnt(4)
    v_mfma_f32_16x16x32_bf16 v[196:199], v[72:75], v[48:51], v[196:199]
    ds_read_b64_tr_b16 v[60:61], v22 offset:61440
    v_min_u32 v35, 0xfffffffe, v35
    v_cvt_pk_bf16_f32 v36, v220, v221
    v_mfma_f32_16x16x32_bf16 v[200:203], v[76:79], v[48:51], v[200:203]
    buffer_store_dwordx4 v[32:35], v234, s[32:35], 0 offen offset:0 sc0 sc1
    v_min_u32 v36, 0xfffffffe, v36
    v_cvt_pk_bf16_f32 v37, v222, v223
    v_mfma_f32_16x16x32_bf16 v[204:207], v[80:83], v[48:51], v[204:207]
    ds_read_b64_tr_b16 v[62:63], v22 offset:61952
    v_min_u32 v37, 0xfffffffe, v37
    v_cvt_pk_bf16_f32 v38, v224, v225
    v_mfma_f32_16x16x32_bf16 v[208:211], v[84:87], v[48:51], v[208:211]
    v_min_u32 v38, 0xfffffffe, v38
    v_cvt_pk_bf16_f32 v39, v226, v227
    s_waitcnt lgkmcnt(4)
    v_mfma_f32_16x16x32_bf16 v[196:199], v[76:79], v[52:55], v[196:199]
    ds_read_b64_tr_b16 v[48:49], v24 offset:0
    v_min_u32 v39, 0xfffffffe, v39
    v_mfma_f32_16x16x32_bf16 v[200:203], v[80:83], v[52:55], v[200:203]
    buffer_store_dwordx4 v[36:39], v234, s[32:35], 0 offen offset:1024 sc0 sc1
    v_mfma_f32_16x16x32_bf16 v[204:207], v[84:87], v[52:55], v[204:207]
    ds_read_b64_tr_b16 v[50:51], v24 offset:512
    v_mfma_f32_16x16x32_bf16 v[208:211], v[88:91], v[52:55], v[208:211]
    s_waitcnt lgkmcnt(4)
    v_mfma_f32_16x16x32_bf16 v[196:199], v[80:83], v[56:59], v[196:199]
    ds_read_b64_tr_b16 v[52:53], v24 offset:4096
    v_mfma_f32_16x16x32_bf16 v[200:203], v[84:87], v[56:59], v[200:203]
    v_mfma_f32_16x16x32_bf16 v[204:207], v[88:91], v[56:59], v[204:207]
    ds_read_b64_tr_b16 v[54:55], v24 offset:4608
    v_mfma_f32_16x16x32_bf16 v[208:211], v[92:95], v[56:59], v[208:211]
    s_waitcnt lgkmcnt(4)
    v_mfma_f32_16x16x32_bf16 v[196:199], v[84:87], v[60:63], v[196:199]
    ds_read_b64_tr_b16 v[56:57], v24 offset:8192
    v_mfma_f32_16x16x32_bf16 v[200:203], v[88:91], v[60:63], v[200:203]
    v_mfma_f32_16x16x32_bf16 v[204:207], v[92:95], v[60:63], v[204:207]
    ds_read_b64_tr_b16 v[58:59], v24 offset:8704
    v_mfma_f32_16x16x32_bf16 v[208:211], v[96:99], v[60:63], v[208:211]
    s_waitcnt lgkmcnt(4)
    v_mfma_f32_16x16x32_bf16 v[196:199], v[88:91], v[48:51], v[196:199]
    ds_read_b64_tr_b16 v[60:61], v24 offset:12288
    v_mfma_f32_16x16x32_bf16 v[200:203], v[92:95], v[48:51], v[200:203]
    v_mfma_f32_16x16x32_bf16 v[204:207], v[96:99], v[48:51], v[204:207]
    ds_read_b64_tr_b16 v[62:63], v24 offset:12800
    v_mfma_f32_16x16x32_bf16 v[208:211], v[100:103], v[48:51], v[208:211]
    s_waitcnt lgkmcnt(4)
    v_mfma_f32_16x16x32_bf16 v[196:199], v[92:95], v[52:55], v[196:199]
    ds_read_b64_tr_b16 v[48:49], v22 offset:0
    v_mfma_f32_16x16x32_bf16 v[200:203], v[96:99], v[52:55], v[200:203]
    v_mfma_f32_16x16x32_bf16 v[204:207], v[100:103], v[52:55], v[204:207]
    ds_read_b64_tr_b16 v[50:51], v22 offset:512
    v_mfma_f32_16x16x32_bf16 v[208:211], v[104:107], v[52:55], v[208:211]
    s_waitcnt lgkmcnt(4)
    v_mfma_f32_16x16x32_bf16 v[196:199], v[108:111], v[56:59], v[196:199]
    ds_read_b64_tr_b16 v[52:53], v22 offset:4096
    v_mfma_f32_16x16x32_bf16 v[200:203], v[112:115], v[56:59], v[200:203]
    v_mfma_f32_16x16x32_bf16 v[204:207], v[116:119], v[56:59], v[204:207]
    ds_read_b64_tr_b16 v[54:55], v22 offset:4608
    v_mfma_f32_16x16x32_bf16 v[208:211], v[120:123], v[56:59], v[208:211]
    s_waitcnt lgkmcnt(4)
    v_mfma_f32_16x16x32_bf16 v[196:199], v[112:115], v[60:63], v[196:199]
    ds_read_b64_tr_b16 v[56:57], v22 offset:8192
    v_mfma_f32_16x16x32_bf16 v[200:203], v[116:119], v[60:63], v[200:203]
    v_mfma_f32_16x16x32_bf16 v[204:207], v[120:123], v[60:63], v[204:207]
    ds_read_b64_tr_b16 v[58:59], v22 offset:8704
    v_mfma_f32_16x16x32_bf16 v[208:211], v[124:127], v[60:63], v[208:211]
    buffer_load_dwordx2 v[246:247], v236, s[36:39], 0 offen sc1
    global_load_ushort v242, v245, s[10:11]
    global_load_ushort v243, v245, s[12:13]
    global_load_ushort v244, v245, s[8:9]
    s_waitcnt lgkmcnt(4)
    v_mfma_f32_16x16x32_bf16 v[196:199], v[116:119], v[48:51], v[196:199]
    ds_read_b64_tr_b16 v[60:61], v22 offset:12288
    v_mfma_f32_16x16x32_bf16 v[200:203], v[120:123], v[48:51], v[200:203]
    v_mfma_f32_16x16x32_bf16 v[204:207], v[124:127], v[48:51], v[204:207]
    ds_read_b64_tr_b16 v[62:63], v22 offset:12800
    v_mfma_f32_16x16x32_bf16 v[208:211], v[128:131], v[48:51], v[208:211]
    s_waitcnt lgkmcnt(4)
    v_mfma_f32_16x16x32_bf16 v[196:199], v[120:123], v[52:55], v[196:199]
    ds_read_b64_tr_b16 v[48:49], v20 offset:0
    v_mfma_f32_16x16x32_bf16 v[200:203], v[124:127], v[52:55], v[200:203]
    v_mfma_f32_16x16x32_bf16 v[204:207], v[128:131], v[52:55], v[204:207]
    ds_read_b64_tr_b16 v[50:51], v20 offset:512
    v_mfma_f32_16x16x32_bf16 v[208:211], v[132:135], v[52:55], v[208:211]
    s_waitcnt lgkmcnt(4)
    v_mfma_f32_16x16x32_bf16 v[196:199], v[124:127], v[56:59], v[196:199]
    ds_read_b64_tr_b16 v[52:53], v20 offset:4096
    v_mfma_f32_16x16x32_bf16 v[200:203], v[128:131], v[56:59], v[200:203]
    v_mfma_f32_16x16x32_bf16 v[204:207], v[132:135], v[56:59], v[204:207]
    ds_read_b64_tr_b16 v[54:55], v20 offset:4608
    v_mfma_f32_16x16x32_bf16 v[208:211], v[136:139], v[56:59], v[208:211]
    s_waitcnt lgkmcnt(4)
    v_mfma_f32_16x16x32_bf16 v[196:199], v[128:131], v[60:63], v[196:199]
    ds_read_b64_tr_b16 v[56:57], v20 offset:8192
    v_mfma_f32_16x16x32_bf16 v[200:203], v[132:135], v[60:63], v[200:203]
    v_mfma_f32_16x16x32_bf16 v[204:207], v[136:139], v[60:63], v[204:207]
    ds_read_b64_tr_b16 v[58:59], v20 offset:8704
    v_mfma_f32_16x16x32_bf16 v[208:211], v[140:143], v[60:63], v[208:211]
    s_waitcnt lgkmcnt(4)
    v_mfma_f32_16x16x32_bf16 v[196:199], v[132:135], v[48:51], v[196:199]
    ds_read_b64_tr_b16 v[60:61], v20 offset:12288
    v_mfma_f32_16x16x32_bf16 v[200:203], v[136:139], v[48:51], v[200:203]
    v_mfma_f32_16x16x32_bf16 v[204:207], v[140:143], v[48:51], v[204:207]
    ds_read_b64_tr_b16 v[62:63], v20 offset:12800
    v_mfma_f32_16x16x32_bf16 v[208:211], v[144:147], v[48:51], v[208:211]
    s_waitcnt lgkmcnt(4)
    v_mfma_f32_16x16x32_bf16 v[196:199], v[136:139], v[52:55], v[196:199]
    ds_read_b64_tr_b16 v[48:49], v20 offset:16384
    v_mfma_f32_16x16x32_bf16 v[200:203], v[140:143], v[52:55], v[200:203]
    v_mfma_f32_16x16x32_bf16 v[204:207], v[144:147], v[52:55], v[204:207]
    ds_read_b64_tr_b16 v[50:51], v20 offset:16896
    v_mfma_f32_16x16x32_bf16 v[208:211], v[148:151], v[52:55], v[208:211]
    s_waitcnt lgkmcnt(4)
    v_mfma_f32_16x16x32_bf16 v[196:199], v[152:155], v[56:59], v[196:199]
    ds_read_b64_tr_b16 v[52:53], v20 offset:20480
    v_mfma_f32_16x16x32_bf16 v[200:203], v[156:159], v[56:59], v[200:203]
    v_mfma_f32_16x16x32_bf16 v[204:207], v[160:163], v[56:59], v[204:207]
    ds_read_b64_tr_b16 v[54:55], v20 offset:20992
    v_mfma_f32_16x16x32_bf16 v[208:211], v[164:167], v[56:59], v[208:211]
    s_waitcnt lgkmcnt(4)
    v_mfma_f32_16x16x32_bf16 v[196:199], v[156:159], v[60:63], v[196:199]
    ds_read_b64_tr_b16 v[56:57], v20 offset:24576
    v_mfma_f32_16x16x32_bf16 v[200:203], v[160:163], v[60:63], v[200:203]
    v_mfma_f32_16x16x32_bf16 v[204:207], v[164:167], v[60:63], v[204:207]
    ds_read_b64_tr_b16 v[58:59], v20 offset:25088
    v_mfma_f32_16x16x32_bf16 v[208:211], v[168:171], v[60:63], v[208:211]
    s_waitcnt lgkmcnt(4)
    v_mfma_f32_16x16x32_bf16 v[196:199], v[160:163], v[48:51], v[196:199]
    ds_read_b64_tr_b16 v[60:61], v20 offset:28672
    v_mfma_f32_16x16x32_bf16 v[200:203], v[164:167], v[48:51], v[200:203]
    v_mfma_f32_16x16x32_bf16 v[204:207], v[168:171], v[48:51], v[204:207]
    ds_read_b64_tr_b16 v[62:63], v20 offset:29184
    v_mfma_f32_16x16x32_bf16 v[208:211], v[172:175], v[48:51], v[208:211]
    s_waitcnt lgkmcnt(4)
    v_mfma_f32_16x16x32_bf16 v[196:199], v[164:167], v[52:55], v[196:199]
    ds_read_b64_tr_b16 v[48:49], v22 offset:16384
    v_mfma_f32_16x16x32_bf16 v[200:203], v[168:171], v[52:55], v[200:203]
    v_mfma_f32_16x16x32_bf16 v[204:207], v[172:175], v[52:55], v[204:207]
    ds_read_b64_tr_b16 v[50:51], v22 offset:16896
    v_mfma_f32_16x16x32_bf16 v[208:211], v[176:179], v[52:55], v[208:211]
    s_waitcnt lgkmcnt(4)
    v_mfma_f32_16x16x32_bf16 v[196:199], v[168:171], v[56:59], v[196:199]
    ds_read_b64_tr_b16 v[52:53], v22 offset:20480
    v_mfma_f32_16x16x32_bf16 v[200:203], v[172:175], v[56:59], v[200:203]
    v_mfma_f32_16x16x32_bf16 v[204:207], v[176:179], v[56:59], v[204:207]
    ds_read_b64_tr_b16 v[54:55], v22 offset:20992
    v_mfma_f32_16x16x32_bf16 v[208:211], v[180:183], v[56:59], v[208:211]
    s_waitcnt lgkmcnt(4)
    v_mfma_f32_16x16x32_bf16 v[196:199], v[172:175], v[60:63], v[196:199]
    ds_read_b64_tr_b16 v[56:57], v22 offset:24576
    v_mfma_f32_16x16x32_bf16 v[200:203], v[176:179], v[60:63], v[200:203]
    v_mfma_f32_16x16x32_bf16 v[204:207], v[180:183], v[60:63], v[204:207]
    ds_read_b64_tr_b16 v[58:59], v22 offset:25088
    v_mfma_f32_16x16x32_bf16 v[208:211], v[184:187], v[60:63], v[208:211]
    s_waitcnt lgkmcnt(4)
    v_mfma_f32_16x16x32_bf16 v[196:199], v[176:179], v[48:51], v[196:199]
    ds_read_b64_tr_b16 v[60:61], v22 offset:28672
    v_mfma_f32_16x16x32_bf16 v[200:203], v[180:183], v[48:51], v[200:203]
    s_waitcnt vmcnt(0)
    s_mov_b32 s50, 0
L_cnt0:
    v_readfirstlane_b32 s43, v246
    v_readfirstlane_b32 s49, v247
    s_and_b32 s57, s43, 0xff
    s_cmp_ge_u32 s57, 32
    s_cbranch_scc1 L_cntok0
    s_add_u32 s50, s50, 1
    s_cmp_ge_u32 s50, 0x100000
    s_cbranch_scc1 L_cntok0
    buffer_load_dwordx2 v[246:247], v236, s[36:39], 0 offen sc1
    s_waitcnt vmcnt(0)
    s_branch L_cnt0
L_cntok0:
    buffer_load_dwordx4 v[40:43], v235, s[32:35], 0 offen offset:0 sc0 sc1
    buffer_load_dwordx4 v[44:47], v235, s[32:35], 0 offen offset:1024 sc0 sc1
    s_cmp_eq_u32 s59, 0
    s_cselect_b32 s43, s43, s49
    s_lshr_b32 s43, s43, 8
    s_cmp_eq_u32 s43, s0
    s_cselect_b32 s1, 1, 0
    v_mfma_f32_16x16x32_bf16 v[204:207], v[184:187], v[48:51], v[204:207]
    ds_read_b64_tr_b16 v[62:63], v22 offset:29184
    v_mfma_f32_16x16x32_bf16 v[208:211], v[188:191], v[48:51], v[208:211]
    v_lshlrev_b32 v242, 16, v242
    s_waitcnt lgkmcnt(4)
    v_mfma_f32_16x16x32_bf16 v[196:199], a[56:59], v[52:55], v[196:199]
    ds_read_b64_tr_b16 v[48:49], v22 offset:32768
    v_lshlrev_b32 v243, 16, v243
    v_mfma_f32_16x16x32_bf16 v[200:203], a[60:63], v[52:55], v[200:203]
    v_lshlrev_b32 v244, 16, v244
    v_mfma_f32_16x16x32_bf16 v[204:207], a[64:67], v[52:55], v[204:207]
    ds_read_b64_tr_b16 v[50:51], v22 offset:33280
    v_mfma_f32_16x16x32_bf16 v[208:211], a[68:71], v[52:55], v[208:211]
    s_waitcnt lgkmcnt(4)
    v_mfma_f32_16x16x32_bf16 v[196:199], a[60:63], v[56:59], v[196:199]
    ds_read_b64_tr_b16 v[52:53], v22 offset:36864
    v_mfma_f32_16x16x32_bf16 v[200:203], a[64:67], v[56:59], v[200:203]
    v_mfma_f32_16x16x32_bf16 v[204:207], a[68:71], v[56:59], v[204:207]
    ds_read_b64_tr_b16 v[54:55], v22 offset:37376
    v_mfma_f32_16x16x32_bf16 v[208:211], a[72:75], v[56:59], v[208:211]
    s_waitcnt lgkmcnt(4)
    v_mfma_f32_16x16x32_bf16 v[196:199], a[64:67], v[60:63], v[196:199]
    ds_read_b64_tr_b16 v[56:57], v22 offset:40960
    v_mfma_f32_16x16x32_bf16 v[200:203], a[68:71], v[60:63], v[200:203]
    v_mfma_f32_16x16x32_bf16 v[204:207], a[72:75], v[60:63], v[204:207]
    ds_read_b64_tr_b16 v[58:59], v22 offset:41472
    v_mfma_f32_16x16x32_bf16 v[208:211], a[76:79], v[60:63], v[208:211]
    s_waitcnt lgkmcnt(4)
    v_mfma_f32_16x16x32_bf16 v[196:199], a[68:71], v[48:51], v[196:199]
    ds_read_b64_tr_b16 v[60:61], v22 offset:45056
    v_mfma_f32_16x16x32_bf16 v[200:203], a[72:75], v[48:51], v[200:203]
    v_mfma_f32_16x16x32_bf16 v[204:207], a[76:79], v[48:51], v[204:207]
    ds_read_b64_tr_b16 v[62:63], v22 offset:45568
    v_mfma_f32_16x16x32_bf16 v[208:211], a[80:83], v[48:51], v[208:211]
    s_waitcnt lgkmcnt(4)
    v_mfma_f32_16x16x32_bf16 v[196:199], a[72:75], v[52:55], v[196:199]
    v_mfma_f32_16x16x32_bf16 v[200:203], a[76:79], v[52:55], v[200:203]
    v_mfma_f32_16x16x32_bf16 v[204:207], a[80:83], v[52:55], v[204:207]
    v_mfma_f32_16x16x32_bf16 v[208:211], a[84:87], v[52:55], v[208:211]
    s_waitcnt lgkmcnt(2)
    v_mfma_f32_16x16x32_bf16 v[196:199], a[76:79], v[56:59], v[196:199]
    v_mfma_f32_16x16x32_bf16 v[200:203], a[80:83], v[56:59], v[200:203]
    v_mfma_f32_16x16x32_bf16 v[204:207], a[84:87], v[56:59], v[204:207]
    v_mfma_f32_16x16x32_bf16 v[208:211], a[88:91], v[56:59], v[208:211]
    s_waitcnt lgkmcnt(0)
    v_mfma_f32_16x16x32_bf16 v[196:199], a[80:83], v[60:63], v[196:199]
    v_mfma_f32_16x16x32_bf16 v[200:203], a[84:87], v[60:63], v[200:203]
    v_mfma_f32_16x16x32_bf16 v[204:207], a[88:91], v[60:63], v[204:207]
    v_mfma_f32_16x16x32_bf16 v[208:211], a[92:95], v[60:63], v[208:211]
L_epi:
L_inb:
    s_waitcnt vmcnt(0)
    v_max3_u32 v96, v40, v41, v42
    v_max3_u32 v97, v43, v44, v45
    v_max3_u32 v96, v96, v46, v47
    v_max_u32 v96, v96, v97
    v_cmp_eq_u32 vcc, -1, v96
    v_lshlrev_b32 v212, 16, v40
    v_and_b32 v213, 0xffff0000, v40
    v_lshlrev_b32 v214, 16, v41
    v_and_b32 v215, 0xffff0000, v41
    v_lshlrev_b32 v216, 16, v42
    v_and_b32 v217, 0xffff0000, v42
    v_lshlrev_b32 v218, 16, v43
    v_and_b32 v219, 0xffff0000, v43
    v_lshlrev_b32 v220, 16, v44
    v_and_b32 v221, 0xffff0000, v44
    v_lshlrev_b32 v222, 16, v45
    v_and_b32 v223, 0xffff0000, v45
    v_lshlrev_b32 v224, 16, v46
    v_and_b32 v225, 0xffff0000, v46
    v_lshlrev_b32 v226, 16, v47
    v_and_b32 v227, 0xffff0000, v47
    s_cbranch_vccz L_inbok
    s_add_u32 s50, s50, 1
    s_cmp_ge_u32 s50, 0x100000
    s_cbranch_scc1 L_inbok
    buffer_load_dwordx4 v[40:43], v235, s[32:35], 0 offen offset:0 sc0 sc1
    buffer_load_dwordx4 v[44:47], v235, s[32:35], 0 offen offset:1024 sc0 sc1
    s_branch L_inb
L_inbok:
    v_pk_add_f32 v[196:197], v[196:197], v[212:213]
    v_pk_add_f32 v[198:199], v[198:199], v[214:215]
    v_pk_add_f32 v[200:201], v[200:201], v[216:217]
    v_pk_add_f32 v[202:203], v[202:203], v[218:219]
    v_pk_add_f32 v[204:205], v[204:205], v[220:221]
    v_pk_add_f32 v[206:207], v[206:207], v[222:223]
    v_pk_add_f32 v[208:209], v[208:209], v[224:225]
    v_pk_add_f32 v[210:211], v[210:211], v[226:227]
    s_cmp_lg_u32 s46, 15
    s_cbranch_scc1 L_nomask
    v_cndmask_b32 v196, 0, v196, s[60:61]
    v_cndmask_b32 v197, 0, v197, s[62:63]
    v_cndmask_b32 v198, 0, v198, s[64:65]
    v_cndmask_b32 v199, 0, v199, s[66:67]
    v_cndmask_b32 v200, 0, v200, s[68:69]
    v_cndmask_b32 v201, 0, v201, s[70:71]
    v_cndmask_b32 v202, 0, v202, s[72:73]
    v_cndmask_b32 v203, 0, v203, s[74:75]
    v_cndmask_b32 v204, 0, v204, s[76:77]
    v_cndmask_b32 v205, 0, v205, s[78:79]
    v_cndmask_b32 v206, 0, v206, s[80:81]
    v_cndmask_b32 v207, 0, v207, s[82:83]
    v_cndmask_b32 v208, 0, v208, s[84:85]
    v_cndmask_b32 v209, 0, v209, s[86:87]
    v_cndmask_b32 v210, 0, v210, s[88:89]
    v_cndmask_b32 v211, 0, v211, s[90:91]
L_nomask:
    v_pk_add_f32 v[96:97], v[196:197], v[198:199]
    v_pk_add_f32 v[98:99], v[200:201], v[202:203]
    v_pk_mul_f32 v[100:101], v[196:197], v[196:197]
    v_pk_mul_f32 v[102:103], v[198:199], v[198:199]
    v_pk_add_f32 v[96:97], v[96:97], v[204:205]
    v_pk_add_f32 v[98:99], v[98:99], v[206:207]
    v_pk_add_f32 v[96:97], v[96:97], v[208:209]
    v_pk_add_f32 v[98:99], v[98:99], v[210:211]
    v_pk_fma_f32 v[100:101], v[200:201], v[200:201], v[100:101]
    v_pk_fma_f32 v[102:103], v[202:203], v[202:203], v[102:103]
    v_pk_fma_f32 v[100:101], v[204:205], v[204:205], v[100:101]
    v_pk_fma_f32 v[102:103], v[206:207], v[206:207], v[102:103]
    v_pk_fma_f32 v[100:101], v[208:209], v[208:209], v[100:101]
    v_pk_fma_f32 v[102:103], v[210:211], v[210:211], v[102:103]
    v_pk_add_f32 v[96:97], v[96:97], v[98:99]
    v_pk_add_f32 v[100:101], v[100:101], v[102:103]
    v_add_f32 v96, v96, v97
    v_add_f32 v100, v100, v101
    s_nop 1
    v_permlane32_swap_b32 v96, v100
    s_nop 1
    v_add_f32 v96, v96, v100
    v_add_f32 v97, v96, 0
    s_nop 1
    v_permlane16_swap_b32 v96, v97
    s_nop 1
    v_add_f32 v96, v96, v97
    ds_write_b32 v249, v96
    s_waitcnt lgkmcnt(0)
    s_barrier
    s_cmp_lg_u32 s40, 0
    s_cbranch_scc1 L_nopub
    ds_read2_b32 v[98:99], v248 offset0:0 offset1:64
    s_cmp_eq_u32 s1, 1
    s_waitcnt lgkmcnt(0)
    v_add_f32 v98, v98, v99
    v_min_u32 v98, 0xfffffffe, v98
    s_cbranch_scc1 L_pubfast
    buffer_store_dword v98, v233, s[32:35], 0 offen sc0 sc1
    s_branch L_nopub
L_pubfast:
    buffer_store_dword v98, v233, s[32:35], 0 offen
L_nopub:
    s_mov_b32 s43, 0x3a038849
    s_mov_b32 s49, 0x3727c5ac
    v_mov_b32 v112, 0xc0135761
    v_mov_b32 v114, 0xbdd2d3e8
L_poll:
    buffer_load_dwordx2 v[88:89], v239, s[32:35], s52 offen sc0 sc1
    buffer_load_dwordx2 v[90:91], v239, s[32:35], s53 offen sc0 sc1
    buffer_load_dwordx2 v[92:93], v239, s[32:35], s54 offen sc0 sc1
    buffer_load_dwordx2 v[94:95], v239, s[32:35], s55 offen sc0 sc1
    s_add_u32 s50, s50, 1
    s_waitcnt vmcnt(0)
    v_max3_u32 v100, v88, v89, v90
    v_max3_u32 v101, v91, v92, v93
    v_max3_u32 v100, v100, v94, v95
    v_max_u32 v100, v100, v101
    v_cmp_eq_u32 vcc, -1, v100
    v_pk_add_f32 v[88:89], v[88:89], v[90:91]
    v_pk_add_f32 v[92:93], v[92:93], v[94:95]
    v_pk_add_f32 v[88:89], v[88:89], v[92:93]
    s_cmp_ge_u32 s50, 0x100000
    s_cbranch_scc1 L_pollok
    s_cbranch_vccnz L_poll
L_pollok:
    v_mov_b32 v90, v88
    v_mov_b32 v91, v89
    s_nop 1
    v_permlane32_swap_b32 v88, v90
    v_permlane32_swap_b32 v89, v91
    s_nop 1
    v_pk_add_f32 v[88:89], v[88:89], v[90:91]
    v_pk_add_f32 v[92:93], v[88:89], 0
    s_nop 1
    v_permlane16_swap_b32 v88, v92
    v_permlane16_swap_b32 v89, v93
    s_nop 1
    v_pk_add_f32 v[88:89], v[88:89], v[92:93]
    v_mul_f32 v88, s43, v88
    v_mul_f32 v89, s43, v89
    v_fma_f32 v89, -v88, v88, v89
    v_add_f32 v88, v88, v244
    v_max_f32 v89, 0, v89
    v_sub_f32 v88, v88, v244
    v_add_f32 v89, s49, v89
    v_rsq_f32 v89, v89
    s_nop 0
    v_mul_f32 v104, v89, v242
    v_fma_f32 v106, -v88, v104, v243
    v_pk_fma_f32 v[116:117], v[196:197], v[104:105], v[106:107] op_sel_hi:[1,0,0]
    v_pk_fma_f32 v[118:119], v[198:199], v[104:105], v[106:107] op_sel_hi:[1,0,0]
    v_pk_fma_f32 v[120:121], v[200:201], v[104:105], v[106:107] op_sel_hi:[1,0,0]
    v_pk_fma_f32 v[122:123], v[202:203], v[104:105], v[106:107] op_sel_hi:[1,0,0]
    v_pk_mul_f32 v[132:133], v[116:117], v[116:117]
    v_pk_mul_f32 v[134:135], v[118:119], v[118:119]
    v_pk_mul_f32 v[136:137], v[120:121], v[120:121]
    v_pk_mul_f32 v[138:139], v[122:123], v[122:123]
    v_pk_fma_f32 v[132:133], v[132:133], v[114:115], v[112:113] op_sel_hi:[1,0,0]
    v_pk_fma_f32 v[134:135], v[134:135], v[114:115], v[112:113] op_sel_hi:[1,0,0]
    v_pk_fma_f32 v[136:137], v[136:137], v[114:115], v[112:113] op_sel_hi:[1,0,0]
    v_pk_fma_f32 v[138:139], v[138:139], v[114:115], v[112:113] op_sel_hi:[1,0,0]
    v_pk_mul_f32 v[132:133], v[132:133], v[116:117]
    v_pk_mul_f32 v[134:135], v[134:135], v[118:119]
    v_pk_mul_f32 v[136:137], v[136:137], v[120:121]
    v_pk_mul_f32 v[138:139], v[138:139], v[122:123]
    v_exp_f32 v132, v132
    v_exp_f32 v133, v133
    v_exp_f32 v134, v134
    v_exp_f32 v135, v135
    v_exp_f32 v136, v136
    v_exp_f32 v137, v137
    v_exp_f32 v138, v138
    v_exp_f32 v139, v139
    v_pk_add_f32 v[132:133], v[132:133], 1.0 op_sel_hi:[1,0]
    v_pk_add_f32 v[134:135], v[134:135], 1.0 op_sel_hi:[1,0]
    v_pk_add_f32 v[136:137], v[136:137], 1.0 op_sel_hi:[1,0]
    v_pk_add_f32 v[138:139], v[138:139], 1.0 op_sel_hi:[1,0]
    v_rcp_f32 v132, v132
    v_rcp_f32 v133, v133
    v_rcp_f32 v134, v134
    v_rcp_f32 v135, v135
    v_rcp_f32 v136, v136
    v_rcp_f32 v137, v137
    v_rcp_f32 v138, v138
    v_rcp_f32 v139, v139
    v_pk_mul_f32 v[116:117], v[116:117], v[132:133]
    v_pk_mul_f32 v[118:119], v[118:119], v[134:135]
    v_pk_mul_f32 v[120:121], v[120:121], v[136:137]
    v_pk_mul_f32 v[122:123], v[122:123], v[138:139]
    v_cvt_pk_bf16_f32 v148, v116, v120
    v_cvt_pk_bf16_f32 v150, v117, v121
    v_cvt_pk_bf16_f32 v152, v118, v122
    v_cvt_pk_bf16_f32 v154, v119, v123
    s_nop 0
    v_mov_b32_dpp v149, v148 quad_perm:[1,0,3,2] row_mask:0xf bank_mask:0xf
    v_mov_b32_dpp v151, v150 quad_perm:[1,0,3,2] row_mask:0xf bank_mask:0xf
    v_mov_b32_dpp v153, v152 quad_perm:[1,0,3,2] row_mask:0xf bank_mask:0xf
    v_mov_b32_dpp v155, v154 quad_perm:[1,0,3,2] row_mask:0xf bank_mask:0xf
    v_perm_b32 v148, v149, v148, v238
    buffer_store_dword v148, v237, s[28:31], s52 offen offset:0 nt
    v_perm_b32 v150, v151, v150, v238
    buffer_store_dword v150, v237, s[28:31], s53 offen offset:0 nt
    v_perm_b32 v152, v153, v152, v238
    buffer_store_dword v152, v237, s[28:31], s54 offen offset:0 nt
    v_perm_b32 v154, v155, v154, v238
    buffer_store_dword v154, v237, s[28:31], s55 offen offset:0 nt
    v_pk_fma_f32 v[124:125], v[204:205], v[104:105], v[106:107] op_sel_hi:[1,0,0]
    v_pk_fma_f32 v[126:127], v[206:207], v[104:105], v[106:107] op_sel_hi:[1,0,0]
    v_pk_fma_f32 v[128:129], v[208:209], v[104:105], v[106:107] op_sel_hi:[1,0,0]
    v_pk_fma_f32 v[130:131], v[210:211], v[104:105], v[106:107] op_sel_hi:[1,0,0]
    v_pk_mul_f32 v[140:141], v[124:125], v[124:125]
    v_pk_mul_f32 v[142:143], v[126:127], v[126:127]
    v_pk_mul_f32 v[144:145], v[128:129], v[128:129]
    v_pk_mul_f32 v[146:147], v[130:131], v[130:131]
    v_pk_fma_f32 v[140:141], v[140:141], v[114:115], v[112:113] op_sel_hi:[1,0,0]
    v_pk_fma_f32 v[142:143], v[142:143], v[114:115], v[112:113] op_sel_hi:[1,0,0]
    v_pk_fma_f32 v[144:145], v[144:145], v[114:115], v[112:113] op_sel_hi:[1,0,0]
    v_pk_fma_f32 v[146:147], v[146:147], v[114:115], v[112:113] op_sel_hi:[1,0,0]
    v_pk_mul_f32 v[140:141], v[140:141], v[124:125]
    v_pk_mul_f32 v[142:143], v[142:143], v[126:127]
    v_pk_mul_f32 v[144:145], v[144:145], v[128:129]
    v_pk_mul_f32 v[146:147], v[146:147], v[130:131]
    v_exp_f32 v140, v140
    v_exp_f32 v141, v141
    v_exp_f32 v142, v142
    v_exp_f32 v143, v143
    v_exp_f32 v144, v144
    v_exp_f32 v145, v145
    v_exp_f32 v146, v146
    v_exp_f32 v147, v147
    v_pk_add_f32 v[140:141], v[140:141], 1.0 op_sel_hi:[1,0]
    v_pk_add_f32 v[142:143], v[142:143], 1.0 op_sel_hi:[1,0]
    v_pk_add_f32 v[144:145], v[144:145], 1.0 op_sel_hi:[1,0]
    v_pk_add_f32 v[146:147], v[146:147], 1.0 op_sel_hi:[1,0]
    v_rcp_f32 v140, v140
    v_rcp_f32 v141, v141
    v_rcp_f32 v142, v142
    v_rcp_f32 v143, v143
    v_rcp_f32 v144, v144
    v_rcp_f32 v145, v145
    v_rcp_f32 v146, v146
    v_rcp_f32 v147, v147
    v_pk_mul_f32 v[124:125], v[124:125], v[140:141]
    v_pk_mul_f32 v[126:127], v[126:127], v[142:143]
    v_pk_mul_f32 v[128:129], v[128:129], v[144:145]
    v_pk_mul_f32 v[130:131], v[130:131], v[146:147]
    v_cvt_pk_bf16_f32 v156, v124, v128
    v_cvt_pk_bf16_f32 v158, v125, v129
    v_cvt_pk_bf16_f32 v160, v126, v130
    v_cvt_pk_bf16_f32 v162, v127, v131
    s_nop 0
    v_mov_b32_dpp v157, v156 quad_perm:[1,0,3,2] row_mask:0xf bank_mask:0xf
    v_mov_b32_dpp v159, v158 quad_perm:[1,0,3,2] row_mask:0xf bank_mask:0xf
    v_mov_b32_dpp v161, v160 quad_perm:[1,0,3,2] row_mask:0xf bank_mask:0xf
    v_mov_b32_dpp v163, v162 quad_perm:[1,0,3,2] row_mask:0xf bank_mask:0xf
    v_perm_b32 v156, v157, v156, v238
    buffer_store_dword v156, v237, s[28:31], s52 offen offset:1024 nt
    v_perm_b32 v158, v159, v158, v238
    buffer_store_dword v158, v237, s[28:31], s53 offen offset:1024 nt
    v_perm_b32 v160, v161, v160, v238
    buffer_store_dword v160, v237, s[28:31], s54 offen offset:1024 nt
    v_perm_b32 v162, v163, v162, v238
    buffer_store_dword v162, v237, s[28:31], s55 offen offset:1024 nt
L_end:
    s_endpgm
.section .rodata,"a"
.p2align 6
.amdhsa_kernel standalone__self_sup_conv_stem_hubert__speech_kernel
  .amdhsa_next_free_vgpr 356
  .amdhsa_next_free_sgpr 102
  .amdhsa_accum_offset 256
  .amdhsa_group_segment_fixed_size 0
  .amdhsa_kernarg_size 64
  .amdhsa_user_sgpr_count 2
  .amdhsa_user_sgpr_kernarg_segment_ptr 1
  .amdhsa_system_sgpr_workgroup_id_x 1
  .amdhsa_float_denorm_mode_32 3
.end_amdhsa_kernel
```
